```python
import torch

def _softmax(x, axis=-1):
    return torch.softmax(x, dim=axis)
def _gelu(x):
    return torch.nn.functional.gelu(x, approximate="tanh")
def _silu(x):
    return torch.nn.functional.silu(x)
def _sigmoid(x):
    return torch.sigmoid(x)
def _layernorm(x, axis=-1, eps=1e-5):
    m = x.mean(dim=axis, keepdim=True)
    v = x.var(dim=axis, keepdim=True, unbiased=False)
    return (x - m) / torch.sqrt(v + eps)
def _scatter_add(tgt, idx, src, axis=0):
    return tgt.clone().index_add_(axis, idx, src)
def _segment_sum(src, seg, n):
    out = torch.zeros((n,) + src.shape[1:], dtype=src.dtype)
    return out.index_add_(0, seg, src)
def _pad(x, pw):
    flat = tuple(v for pair in reversed(pw) for v in pair)
    return torch.nn.functional.pad(x, flat)

kernel_name = 'gated_mix__gqa_block_cached__swiglu_ffn__decode'

def setup_inputs():

    _w = (lambda a: (lambda t: t.to(torch.bfloat16) if t.is_floating_point() else t)(torch.as_tensor(a)))
    def _A_setup():
        B, Sq, D = 1, 1, 448
        Hq, Hkv, Sk, Dh = 16, 8, 65536, 256
        assert Hq % Hkv == 0, (Hq, Hkv)
        return {
            "x": _w((lambda *s: torch.randn(*s, dtype=torch.bfloat16) * 0.05)(B, Sq, D)),
            "k_cache": _w((lambda *s: torch.randn(*s, dtype=torch.bfloat16) * 6.4)(B, Hkv, Sk, Dh)),
            "v_cache": _w((lambda *s: torch.randn(*s, dtype=torch.bfloat16) * 0.2)(B, Hkv, Sk, Dh)),
            "wq": _w((lambda *s: torch.randn(*s, dtype=torch.bfloat16) * 6.4)(D, Hq * Dh) * (D ** -0.5)),
            "wo": _w((lambda *s: torch.randn(*s, dtype=torch.bfloat16) * 0.2)(Hq * Dh, D) * ((Hq * Dh) ** -0.5)),
        }
    _A_in = _A_setup()

    def _B_setup():
        B, S, D, F = 1, 1, 448, 1792
        return {
            "x": _w((lambda *s: torch.randn(*s, dtype=torch.bfloat16) * 0.05)(B, S, D)),
            "w_gate": _w((lambda *s: torch.randn(*s, dtype=torch.bfloat16) * 0.05)(D, F)),
            "w_up": _w((lambda *s: torch.randn(*s, dtype=torch.bfloat16) * 0.05)(D, F)),
            "w_down": _w((lambda *s: torch.randn(*s, dtype=torch.bfloat16) * 0.05)(F, D)),
        }
    _B_in = _B_setup()

    return {
        "A_x": _A_in["x"],
        "A_k_cache": _A_in["k_cache"],
        "A_v_cache": _A_in["v_cache"],
        "A_wq": _A_in["wq"],
        "A_wo": _A_in["wo"],
        "B_x": _B_in["x"],
        "B_w_gate": _B_in["w_gate"],
        "B_w_up": _B_in["w_up"],
        "B_w_down": _B_in["w_down"],
        "gate_w": _w((lambda *s: torch.randn(*s, dtype=torch.bfloat16) * 0.05)(448) * 16.0),
    }

def reference(A_x, A_k_cache, A_v_cache, A_wq, A_wo, B_x, B_w_gate, B_w_up, B_w_down, gate_w):
    def _A_ref(x, k_cache, v_cache, wq, wo):
        B, Sq, D = x.shape
        Hq, Dh = 16, 256
        Hkv = k_cache.shape[1]
        rep = Hq // Hkv
        q = (lambda x, *d: x.permute(*d))((x @ wq).reshape(B, Sq, Hq, Dh), 0, 2, 1, 3)
        k = (lambda x, n, axis: torch.repeat_interleave(x, n, dim=axis))(k_cache, rep, axis=1)
        v = (lambda x, n, axis: torch.repeat_interleave(x, n, dim=axis))(v_cache, rep, axis=1)
        scores = torch.einsum("bhqd,bhkd->bhqk", q, k) * (Dh ** -0.5)
        p = _softmax(scores, axis=-1)
        o = torch.einsum("bhqk,bhkd->bhqd", p, v)
        return (lambda x, *d: x.permute(*d))(o, 0, 2, 1, 3).reshape(B, Sq, Hq * Dh) @ wo

    def _B_ref(x, w_gate, w_up, w_down):
        g = _silu(x @ w_gate)
        u = x @ w_up
        return (g * u) @ w_down

    x = A_x
    g = _sigmoid((x * gate_w).sum(-1, keepdims=True))
    a = _A_ref(x, A_k_cache, A_v_cache, A_wq, A_wo)
    b = _B_ref(x, B_w_gate, B_w_up, B_w_down)
    return g * a + (1 - g) * b
```

```asm
; @launch grid=(256,1,1) block=(320,1,1) lds=18560
.amdgcn_target "amdgcn-amd-amdhsa--gfx950"
.text
.globl gated_mix__gqa_block_cached__swiglu_ffn__decode_kernel
.p2align 8
.type gated_mix__gqa_block_cached__swiglu_ffn__decode_kernel,@function
gated_mix__gqa_block_cached__swiglu_ffn__decode_kernel:
  s_load_dwordx16 s[64:79], s[0:1], 0
  s_load_dwordx8 s[80:87], s[0:1], 64
  s_load_dwordx2 s[88:89], s[0:1], 96
  v_readfirstlane_b32 s3, v0
  s_cmp_ge_u32 s2, 256
  s_cbranch_scc1 L_end
  v_and_b32 v7, 63, v0
  s_and_b32 s54, s2, 7
  s_lshr_b32 s55, s2, 3
  s_lshr_b32 s3, s3, 6
  s_cmp_eq_u32 s3, 4
  s_cbranch_scc1 L_helper
  s_and_b32 s29, s55, 1
  s_lshl_b32 s29, s29, 14
  s_and_b32 s23, s3, 1
  s_lshl_b32 s23, s23, 11
  s_or_b32 s29, s29, s23
  s_lshr_b32 s23, s3, 1
  s_lshl_b32 s23, s23, 13
  s_or_b32 s29, s29, s23
  v_lshrrev_b32 v8, 4, v7
  v_and_b32 v9, 3, v7
  v_lshlrev_b32 v9, 4, v9
  v_lshl_add_u32 v9, v8, 6, v9
  v_bfe_u32 v10, v7, 2, 1
  v_lshl_add_u32 v10, v10, 9, v9
  v_bfe_u32 v11, v7, 3, 1
  v_lshl_add_u32 v10, v11, 12, v10
  v_add_u32 v1, s29, v10
  s_lshr_b32 s22, s55, 1
  s_lshl4_add_u32 s22, s54, s22
  s_lshl_b32 s22, s22, 21
  s_mov_b32 s28, 0x8000
  s_mov_b32 s16, 0
  s_mov_b32 s10, 0x200000
  s_mov_b32 s11, 0x20000
  s_waitcnt lgkmcnt(0)
  s_add_u32 s8, s66, s22
  s_addc_u32 s9, s67, 0
  buffer_load_dwordx4 v[192:195], v1, s[8:11], s16 offen offset:0 nt
  buffer_load_dwordx4 v[196:199], v1, s[8:11], s16 offen offset:256 nt
  buffer_load_dwordx4 v[200:203], v1, s[8:11], s16 offen offset:1024 nt
  buffer_load_dwordx4 v[204:207], v1, s[8:11], s16 offen offset:1280 nt
  s_add_u32 s16, s16, s28
  buffer_load_dwordx4 v[208:211], v1, s[8:11], s16 offen offset:0 nt
  s_branch L_spro
L_helper:
  s_getpc_b64 s[4:5]
L_pc:
  s_lshl_b32 s6, s55, 10
  s_min_u32 s6, s6, L_codeend-L_pc-1024
  v_lshl_add_u32 v1, v7, 4, s6
  global_load_dword v22, v1, s[4:5]
  s_bfe_u32 s56, s55, 0x10001
  s_lshr_b32 s57, s55, 2
  s_mul_i32 s59, s56, 448
  v_lshrrev_b32 v3, 3, v7
  v_and_b32 v4, 7, v7
  v_mul_u32_u24 v2, 56, v3
  v_add_u32 v2, s59, v2
  s_lshl3_add_u32 s58, s54, s57
  s_and_b32 s59, s57, 3
  s_lshl2_add_u32 s59, s54, s59
  s_cmp_lt_u32 s54, 7
  s_cselect_b32 s42, 1605632, 0
  s_movk_i32 s61, 4096
  s_bitcmp1_b32 s55, 0
  s_cselect_b32 s58, s59, s58
  s_cselect_b32 s42, s42, 3670016
  s_cselect_b32 s61, 1792, s61
  v_mul_lo_u32 v1, v2, s61
  s_lshl_b32 s58, s58, 7
  v_lshl_add_u32 v1, v4, 4, v1
  s_lshl_b32 s61, s61, 1
  s_mov_b32 s43, 0x20000
  s_movk_i32 s46, 896
  s_mov_b32 s47, s43
  s_cmp_ge_u32 s57, 4
  s_waitcnt lgkmcnt(0)
  s_cselect_b64 s[40:41], s[78:79], s[76:77]
  s_bitcmp1_b32 s55, 0
  s_cselect_b64 s[40:41], s[40:41], s[70:71]
  s_mov_b64 s[44:45], s[64:65]
  s_load_dword s30, s[88:89], 262144
  buffer_load_dwordx4 v[8:11], v2, s[44:47], 0 offen offset:0
  buffer_load_dwordx4 v[12:15], v2, s[44:47], 0 offen offset:16
  buffer_load_dwordx4 v[16:19], v2, s[44:47], 0 offen offset:32
  buffer_load_dwordx2 v[20:21], v2, s[44:47], 0 offen offset:48
  buffer_load_dwordx4 v[80:83], v1, s[40:43], s58 offen nt
  s_add_u32 s58, s58, s61
  buffer_load_dwordx4 v[84:87], v1, s[40:43], s58 offen nt
  s_add_u32 s58, s58, s61
  buffer_load_dwordx4 v[88:91], v1, s[40:43], s58 offen nt
  s_add_u32 s58, s58, s61
  buffer_load_dwordx4 v[92:95], v1, s[40:43], s58 offen nt
  s_add_u32 s58, s58, s61
  buffer_load_dwordx4 v[96:99], v1, s[40:43], s58 offen nt
  s_add_u32 s58, s58, s61
  buffer_load_dwordx4 v[100:103], v1, s[40:43], s58 offen nt
  s_add_u32 s58, s58, s61
  buffer_load_dwordx4 v[104:107], v1, s[40:43], s58 offen nt
  s_add_u32 s58, s58, s61
  buffer_load_dwordx4 v[108:111], v1, s[40:43], s58 offen nt
  s_add_u32 s58, s58, s61
  buffer_load_dwordx4 v[112:115], v1, s[40:43], s58 offen nt
  s_add_u32 s58, s58, s61
  buffer_load_dwordx4 v[116:119], v1, s[40:43], s58 offen nt
  s_add_u32 s58, s58, s61
  buffer_load_dwordx4 v[120:123], v1, s[40:43], s58 offen nt
  s_add_u32 s58, s58, s61
  buffer_load_dwordx4 v[124:127], v1, s[40:43], s58 offen nt
  s_add_u32 s58, s58, s61
  buffer_load_dwordx4 v[128:131], v1, s[40:43], s58 offen nt
  s_add_u32 s58, s58, s61
  buffer_load_dwordx4 v[132:135], v1, s[40:43], s58 offen nt
  s_add_u32 s58, s58, s61
  buffer_load_dwordx4 v[136:139], v1, s[40:43], s58 offen nt
  s_add_u32 s58, s58, s61
  buffer_load_dwordx4 v[140:143], v1, s[40:43], s58 offen nt
  s_add_u32 s58, s58, s61
  buffer_load_dwordx4 v[144:147], v1, s[40:43], s58 offen nt
  s_add_u32 s58, s58, s61
  buffer_load_dwordx4 v[148:151], v1, s[40:43], s58 offen nt
  s_add_u32 s58, s58, s61
  buffer_load_dwordx4 v[152:155], v1, s[40:43], s58 offen nt
  s_add_u32 s58, s58, s61
  buffer_load_dwordx4 v[156:159], v1, s[40:43], s58 offen nt
  s_add_u32 s58, s58, s61
  buffer_load_dwordx4 v[160:163], v1, s[40:43], s58 offen nt
  s_add_u32 s58, s58, s61
  buffer_load_dwordx4 v[164:167], v1, s[40:43], s58 offen nt
  s_add_u32 s58, s58, s61
  buffer_load_dwordx4 v[168:171], v1, s[40:43], s58 offen nt
  s_add_u32 s58, s58, s61
  buffer_load_dwordx4 v[172:175], v1, s[40:43], s58 offen nt
  s_add_u32 s58, s58, s61
  buffer_load_dwordx4 v[176:179], v1, s[40:43], s58 offen nt
  s_add_u32 s58, s58, s61
  buffer_load_dwordx4 v[180:183], v1, s[40:43], s58 offen nt
  s_add_u32 s58, s58, s61
  buffer_load_dwordx4 v[184:187], v1, s[40:43], s58 offen nt
  s_add_u32 s58, s58, s61
  buffer_load_dwordx4 v[188:191], v1, s[40:43], s58 offen nt
  s_setprio 3
  s_mov_b32 s32, s88
  s_mov_b32 s33, s89
  s_mov_b32 s34, 1662976
  s_mov_b32 s35, 0x20000
  s_lshl_b32 s98, s54, 5
  s_add_u32 s98, s98, s55
  s_getreg_b32 s93, hwreg(HW_REG_XCC_ID, 0, 4)
  s_mul_i32 s62, s98, 4224
  s_add_u32 s62, s62, 299008
  s_add_u32 s63, s62, 4096
  v_lshlrev_b32 v5, 4, v7
  buffer_load_dwordx4 v[208:211], v5, s[32:35], s62 offen offset:0 nt
  buffer_load_dwordx4 v[212:215], v5, s[32:35], s62 offen offset:1024 nt
  buffer_load_dwordx4 v[216:219], v5, s[32:35], s62 offen offset:2048 nt
  buffer_load_dwordx4 v[220:223], v5, s[32:35], s62 offen offset:3072 nt
  buffer_load_dword v224, off, s[32:35], s63 nt
  buffer_load_dwordx4 v[228:231], v5, s[32:35], s62 offen offset:0 sc1
  buffer_load_dwordx4 v[232:235], v5, s[32:35], s62 offen offset:1024 sc1
  buffer_load_dwordx4 v[236:239], v5, s[32:35], s62 offen offset:2048 sc1
  buffer_load_dwordx4 v[240:243], v5, s[32:35], s62 offen offset:3072 sc1
  buffer_load_dword v244, off, s[32:35], s63 sc1
  s_lshl_b32 s99, s54, 8
  s_add_u32 s99, s99, 294912
  s_lshl2_add_u32 s95, s55, s99
  v_mov_b32 v6, 0
  v_lshlrev_b32 v5, 7, v7
  s_mov_b64 exec, 3
  buffer_store_dword v6, v5, s[32:35], s95 offen
  s_mul_i32 s62, s55, 768
  s_add_u32 s63, s62, 1380352
  s_cmp_eq_u32 s54, 0
  s_cselect_b32 s62, s63, 1073741824
  v_mov_b32 v5, s62
  s_mov_b64 exec, 1
  buffer_store_dword v6, v5, s[32:35], 0 offen sc1
  s_mov_b64 exec, -1
  v_lshl_add_u32 v6, v4, 3, v3
  v_lshlrev_b32 v6, 3, v6
  s_lshl_b32 s62, s54, 14
  s_and_b32 s63, s55, 1
  s_lshl_b32 s63, s63, 13
  s_add_u32 s62, s62, s63
  s_lshl_b32 s63, s56, 12
  s_add_u32 s62, s62, s63
  s_lshl_b32 s63, s57, 9
  s_add_u32 s62, s62, s63
  v_and_b32 v253, 31, v7
  s_lshl_b32 s63, s54, 8
  s_add_u32 s63, s63, 263168
  v_lshl_add_u32 v253, v253, 3, s63
  s_lshl3_add_u32 s63, s55, s63
  v_mov_b32 v192, 0
  v_mov_b32 v193, 0
  v_mov_b32 v194, 0
  v_mov_b32 v195, 0
  v_mov_b32 v196, 0
  v_mov_b32 v197, 0
  v_mov_b32 v198, 0
  v_mov_b32 v199, 0
  v_mov_b32 v200, s93
  s_waitcnt lgkmcnt(0)
  s_add_u32 s90, s30, 2
  s_add_u32 s30, s30, 1
  s_mov_b32 s31, s30
  v_mov_b32 v201, s30
  s_mov_b64 exec, 1
  buffer_store_dwordx2 v[200:201], off, s[32:35], s63
  s_mov_b64 exec, -1
  s_waitcnt vmcnt(41)
  v_and_b32 v24, 0xffff, v8
  v_lshlrev_b32 v52, 16, v8
  v_lshrrev_b32 v25, 16, v8
  v_and_b32 v53, 0xffff0000, v8
  v_and_b32 v26, 0xffff, v9
  v_lshlrev_b32 v54, 16, v9
  v_lshrrev_b32 v27, 16, v9
  v_and_b32 v55, 0xffff0000, v9
  v_and_b32 v28, 0xffff, v10
  v_lshlrev_b32 v56, 16, v10
  v_lshrrev_b32 v29, 16, v10
  v_and_b32 v57, 0xffff0000, v10
  v_and_b32 v30, 0xffff, v11
  v_lshlrev_b32 v58, 16, v11
  v_lshrrev_b32 v31, 16, v11
  v_and_b32 v59, 0xffff0000, v11
  v_and_b32 v32, 0xffff, v12
  v_lshlrev_b32 v60, 16, v12
  v_lshrrev_b32 v33, 16, v12
  v_and_b32 v61, 0xffff0000, v12
  v_and_b32 v34, 0xffff, v13
  v_lshlrev_b32 v62, 16, v13
  v_lshrrev_b32 v35, 16, v13
  v_and_b32 v63, 0xffff0000, v13
  v_and_b32 v36, 0xffff, v14
  v_lshlrev_b32 v64, 16, v14
  v_lshrrev_b32 v37, 16, v14
  v_and_b32 v65, 0xffff0000, v14
  v_and_b32 v38, 0xffff, v15
  v_lshlrev_b32 v66, 16, v15
  v_lshrrev_b32 v39, 16, v15
  v_and_b32 v67, 0xffff0000, v15
  v_and_b32 v40, 0xffff, v16
  v_lshlrev_b32 v68, 16, v16
  v_lshrrev_b32 v41, 16, v16
  v_and_b32 v69, 0xffff0000, v16
  v_and_b32 v42, 0xffff, v17
  v_lshlrev_b32 v70, 16, v17
  v_lshrrev_b32 v43, 16, v17
  v_and_b32 v71, 0xffff0000, v17
  v_and_b32 v44, 0xffff, v18
  v_lshlrev_b32 v72, 16, v18
  v_lshrrev_b32 v45, 16, v18
  v_and_b32 v73, 0xffff0000, v18
  v_and_b32 v46, 0xffff, v19
  v_lshlrev_b32 v74, 16, v19
  v_lshrrev_b32 v47, 16, v19
  v_and_b32 v75, 0xffff0000, v19
  v_and_b32 v48, 0xffff, v20
  v_lshlrev_b32 v76, 16, v20
  v_lshrrev_b32 v49, 16, v20
  v_and_b32 v77, 0xffff0000, v20
  v_and_b32 v50, 0xffff, v21
  v_lshlrev_b32 v78, 16, v21
  v_lshrrev_b32 v51, 16, v21
  v_and_b32 v79, 0xffff0000, v21
  s_waitcnt vmcnt(37)
  v_dot2c_f32_bf16 v192, v24, v80
  v_dot2c_f32_bf16 v193, v52, v80
  v_dot2c_f32_bf16 v194, v24, v81
  v_dot2c_f32_bf16 v195, v52, v81
  v_dot2c_f32_bf16 v196, v24, v82
  v_dot2c_f32_bf16 v197, v52, v82
  v_dot2c_f32_bf16 v198, v24, v83
  v_dot2c_f32_bf16 v199, v52, v83
  v_dot2c_f32_bf16 v192, v25, v84
  v_dot2c_f32_bf16 v193, v53, v84
  v_dot2c_f32_bf16 v194, v25, v85
  v_dot2c_f32_bf16 v195, v53, v85
  v_dot2c_f32_bf16 v196, v25, v86
  v_dot2c_f32_bf16 v197, v53, v86
  v_dot2c_f32_bf16 v198, v25, v87
  v_dot2c_f32_bf16 v199, v53, v87
  v_dot2c_f32_bf16 v192, v26, v88
  v_dot2c_f32_bf16 v193, v54, v88
  v_dot2c_f32_bf16 v194, v26, v89
  v_dot2c_f32_bf16 v195, v54, v89
  v_dot2c_f32_bf16 v196, v26, v90
  v_dot2c_f32_bf16 v197, v54, v90
  v_dot2c_f32_bf16 v198, v26, v91
  v_dot2c_f32_bf16 v199, v54, v91
  v_dot2c_f32_bf16 v192, v27, v92
  v_dot2c_f32_bf16 v193, v55, v92
  v_dot2c_f32_bf16 v194, v27, v93
  v_dot2c_f32_bf16 v195, v55, v93
  v_dot2c_f32_bf16 v196, v27, v94
  v_dot2c_f32_bf16 v197, v55, v94
  v_dot2c_f32_bf16 v198, v27, v95
  v_dot2c_f32_bf16 v199, v55, v95
  s_waitcnt vmcnt(33)
  v_dot2c_f32_bf16 v192, v28, v96
  v_dot2c_f32_bf16 v193, v56, v96
  v_dot2c_f32_bf16 v194, v28, v97
  v_dot2c_f32_bf16 v195, v56, v97
  v_dot2c_f32_bf16 v196, v28, v98
  v_dot2c_f32_bf16 v197, v56, v98
  v_dot2c_f32_bf16 v198, v28, v99
  v_dot2c_f32_bf16 v199, v56, v99
  v_dot2c_f32_bf16 v192, v29, v100
  v_dot2c_f32_bf16 v193, v57, v100
  v_dot2c_f32_bf16 v194, v29, v101
  v_dot2c_f32_bf16 v195, v57, v101
  v_dot2c_f32_bf16 v196, v29, v102
  v_dot2c_f32_bf16 v197, v57, v102
  v_dot2c_f32_bf16 v198, v29, v103
  v_dot2c_f32_bf16 v199, v57, v103
  v_dot2c_f32_bf16 v192, v30, v104
  v_dot2c_f32_bf16 v193, v58, v104
  v_dot2c_f32_bf16 v194, v30, v105
  v_dot2c_f32_bf16 v195, v58, v105
  v_dot2c_f32_bf16 v196, v30, v106
  v_dot2c_f32_bf16 v197, v58, v106
  v_dot2c_f32_bf16 v198, v30, v107
  v_dot2c_f32_bf16 v199, v58, v107
  v_dot2c_f32_bf16 v192, v31, v108
  v_dot2c_f32_bf16 v193, v59, v108
  v_dot2c_f32_bf16 v194, v31, v109
  v_dot2c_f32_bf16 v195, v59, v109
  v_dot2c_f32_bf16 v196, v31, v110
  v_dot2c_f32_bf16 v197, v59, v110
  v_dot2c_f32_bf16 v198, v31, v111
  v_dot2c_f32_bf16 v199, v59, v111
  s_waitcnt vmcnt(29)
  buffer_load_dwordx2 v[202:203], v253, s[32:35], 0 offen sc1
  v_dot2c_f32_bf16 v192, v32, v112
  v_dot2c_f32_bf16 v193, v60, v112
  v_dot2c_f32_bf16 v194, v32, v113
  v_dot2c_f32_bf16 v195, v60, v113
  v_dot2c_f32_bf16 v196, v32, v114
  v_dot2c_f32_bf16 v197, v60, v114
  v_dot2c_f32_bf16 v198, v32, v115
  v_dot2c_f32_bf16 v199, v60, v115
  v_dot2c_f32_bf16 v192, v33, v116
  v_dot2c_f32_bf16 v193, v61, v116
  v_dot2c_f32_bf16 v194, v33, v117
  v_dot2c_f32_bf16 v195, v61, v117
  v_dot2c_f32_bf16 v196, v33, v118
  v_dot2c_f32_bf16 v197, v61, v118
  v_dot2c_f32_bf16 v198, v33, v119
  v_dot2c_f32_bf16 v199, v61, v119
  v_dot2c_f32_bf16 v192, v34, v120
  v_dot2c_f32_bf16 v193, v62, v120
  v_dot2c_f32_bf16 v194, v34, v121
  v_dot2c_f32_bf16 v195, v62, v121
  v_dot2c_f32_bf16 v196, v34, v122
  v_dot2c_f32_bf16 v197, v62, v122
  v_dot2c_f32_bf16 v198, v34, v123
  v_dot2c_f32_bf16 v199, v62, v123
  v_dot2c_f32_bf16 v192, v35, v124
  v_dot2c_f32_bf16 v193, v63, v124
  v_dot2c_f32_bf16 v194, v35, v125
  v_dot2c_f32_bf16 v195, v63, v125
  v_dot2c_f32_bf16 v196, v35, v126
  v_dot2c_f32_bf16 v197, v63, v126
  v_dot2c_f32_bf16 v198, v35, v127
  v_dot2c_f32_bf16 v199, v63, v127
  s_waitcnt vmcnt(26)
  v_dot2c_f32_bf16 v192, v36, v128
  v_dot2c_f32_bf16 v193, v64, v128
  v_dot2c_f32_bf16 v194, v36, v129
  v_dot2c_f32_bf16 v195, v64, v129
  v_dot2c_f32_bf16 v196, v36, v130
  v_dot2c_f32_bf16 v197, v64, v130
  v_dot2c_f32_bf16 v198, v36, v131
  v_dot2c_f32_bf16 v199, v64, v131
  v_dot2c_f32_bf16 v192, v37, v132
  v_dot2c_f32_bf16 v193, v65, v132
  v_dot2c_f32_bf16 v194, v37, v133
  v_dot2c_f32_bf16 v195, v65, v133
  v_dot2c_f32_bf16 v196, v37, v134
  v_dot2c_f32_bf16 v197, v65, v134
  v_dot2c_f32_bf16 v198, v37, v135
  v_dot2c_f32_bf16 v199, v65, v135
  v_dot2c_f32_bf16 v192, v38, v136
  v_dot2c_f32_bf16 v193, v66, v136
  v_dot2c_f32_bf16 v194, v38, v137
  v_dot2c_f32_bf16 v195, v66, v137
  v_dot2c_f32_bf16 v196, v38, v138
  v_dot2c_f32_bf16 v197, v66, v138
  v_dot2c_f32_bf16 v198, v38, v139
  v_dot2c_f32_bf16 v199, v66, v139
  v_dot2c_f32_bf16 v192, v39, v140
  v_dot2c_f32_bf16 v193, v67, v140
  v_dot2c_f32_bf16 v194, v39, v141
  v_dot2c_f32_bf16 v195, v67, v141
  v_dot2c_f32_bf16 v196, v39, v142
  v_dot2c_f32_bf16 v197, v67, v142
  v_dot2c_f32_bf16 v198, v39, v143
  v_dot2c_f32_bf16 v199, v67, v143
  s_waitcnt vmcnt(22)
  v_dot2c_f32_bf16 v192, v40, v144
  v_dot2c_f32_bf16 v193, v68, v144
  v_dot2c_f32_bf16 v194, v40, v145
  v_dot2c_f32_bf16 v195, v68, v145
  v_dot2c_f32_bf16 v196, v40, v146
  v_dot2c_f32_bf16 v197, v68, v146
  v_dot2c_f32_bf16 v198, v40, v147
  v_dot2c_f32_bf16 v199, v68, v147
  v_dot2c_f32_bf16 v192, v41, v148
  v_dot2c_f32_bf16 v193, v69, v148
  v_dot2c_f32_bf16 v194, v41, v149
  v_dot2c_f32_bf16 v195, v69, v149
  v_dot2c_f32_bf16 v196, v41, v150
  v_dot2c_f32_bf16 v197, v69, v150
  v_dot2c_f32_bf16 v198, v41, v151
  v_dot2c_f32_bf16 v199, v69, v151
  v_dot2c_f32_bf16 v192, v42, v152
  v_dot2c_f32_bf16 v193, v70, v152
  v_dot2c_f32_bf16 v194, v42, v153
  v_dot2c_f32_bf16 v195, v70, v153
  v_dot2c_f32_bf16 v196, v42, v154
  v_dot2c_f32_bf16 v197, v70, v154
  v_dot2c_f32_bf16 v198, v42, v155
  v_dot2c_f32_bf16 v199, v70, v155
  v_dot2c_f32_bf16 v192, v43, v156
  v_dot2c_f32_bf16 v193, v71, v156
  v_dot2c_f32_bf16 v194, v43, v157
  v_dot2c_f32_bf16 v195, v71, v157
  v_dot2c_f32_bf16 v196, v43, v158
  v_dot2c_f32_bf16 v197, v71, v158
  v_dot2c_f32_bf16 v198, v43, v159
  v_dot2c_f32_bf16 v199, v71, v159
  s_waitcnt vmcnt(18)
  v_dot2c_f32_bf16 v192, v44, v160
  v_dot2c_f32_bf16 v193, v72, v160
  v_dot2c_f32_bf16 v194, v44, v161
  v_dot2c_f32_bf16 v195, v72, v161
  v_dot2c_f32_bf16 v196, v44, v162
  v_dot2c_f32_bf16 v197, v72, v162
  v_dot2c_f32_bf16 v198, v44, v163
  v_dot2c_f32_bf16 v199, v72, v163
  v_dot2c_f32_bf16 v192, v45, v164
  v_dot2c_f32_bf16 v193, v73, v164
  v_dot2c_f32_bf16 v194, v45, v165
  v_dot2c_f32_bf16 v195, v73, v165
  v_dot2c_f32_bf16 v196, v45, v166
  v_dot2c_f32_bf16 v197, v73, v166
  v_dot2c_f32_bf16 v198, v45, v167
  v_dot2c_f32_bf16 v199, v73, v167
  v_dot2c_f32_bf16 v192, v46, v168
  v_dot2c_f32_bf16 v193, v74, v168
  v_dot2c_f32_bf16 v194, v46, v169
  v_dot2c_f32_bf16 v195, v74, v169
  v_dot2c_f32_bf16 v196, v46, v170
  v_dot2c_f32_bf16 v197, v74, v170
  v_dot2c_f32_bf16 v198, v46, v171
  v_dot2c_f32_bf16 v199, v74, v171
  v_dot2c_f32_bf16 v192, v47, v172
  v_dot2c_f32_bf16 v193, v75, v172
  v_dot2c_f32_bf16 v194, v47, v173
  v_dot2c_f32_bf16 v195, v75, v173
  v_dot2c_f32_bf16 v196, v47, v174
  v_dot2c_f32_bf16 v197, v75, v174
  v_dot2c_f32_bf16 v198, v47, v175
  v_dot2c_f32_bf16 v199, v75, v175
  s_waitcnt vmcnt(14)
  v_dot2c_f32_bf16 v192, v48, v176
  v_dot2c_f32_bf16 v193, v76, v176
  v_dot2c_f32_bf16 v194, v48, v177
  v_dot2c_f32_bf16 v195, v76, v177
  v_dot2c_f32_bf16 v196, v48, v178
  v_dot2c_f32_bf16 v197, v76, v178
  v_dot2c_f32_bf16 v198, v48, v179
  v_dot2c_f32_bf16 v199, v76, v179
  v_dot2c_f32_bf16 v192, v49, v180
  v_dot2c_f32_bf16 v193, v77, v180
  v_dot2c_f32_bf16 v194, v49, v181
  v_dot2c_f32_bf16 v195, v77, v181
  v_dot2c_f32_bf16 v196, v49, v182
  v_dot2c_f32_bf16 v197, v77, v182
  v_dot2c_f32_bf16 v198, v49, v183
  v_dot2c_f32_bf16 v199, v77, v183
  v_dot2c_f32_bf16 v192, v50, v184
  v_dot2c_f32_bf16 v193, v78, v184
  v_dot2c_f32_bf16 v194, v50, v185
  v_dot2c_f32_bf16 v195, v78, v185
  v_dot2c_f32_bf16 v196, v50, v186
  v_dot2c_f32_bf16 v197, v78, v186
  v_dot2c_f32_bf16 v198, v50, v187
  v_dot2c_f32_bf16 v199, v78, v187
  v_dot2c_f32_bf16 v192, v51, v188
  v_dot2c_f32_bf16 v193, v79, v188
  v_dot2c_f32_bf16 v194, v51, v189
  v_dot2c_f32_bf16 v195, v79, v189
  v_dot2c_f32_bf16 v196, v51, v190
  v_dot2c_f32_bf16 v197, v79, v190
  v_dot2c_f32_bf16 v198, v51, v191
  v_dot2c_f32_bf16 v199, v79, v191
  v_permlane32_swap_b32 v192, v196
  v_permlane32_swap_b32 v193, v197
  v_permlane32_swap_b32 v194, v198
  v_permlane32_swap_b32 v195, v199
  v_add_f32 v192, v192, v196
  v_add_f32 v193, v193, v197
  v_add_f32 v194, v194, v198
  v_add_f32 v195, v195, v199
  s_nop 0
  v_permlane16_swap_b32 v192, v194
  v_permlane16_swap_b32 v193, v195
  v_add_f32 v192, v192, v194
  v_add_f32 v193, v193, v195
  s_nop 0
  v_add_f32_dpp v200, v192, v192 row_ror:8 row_mask:0xf bank_mask:0x3
  s_nop 1
  v_add_f32_dpp v200, v193, v193 row_ror:8 row_mask:0xf bank_mask:0xc
  s_waitcnt vmcnt(0)
  v_cmp_ne_u32 vcc, s93, v202
  v_cmp_ne_u32 s[56:57], s30, v203
  s_or_b64 vcc, vcc, s[56:57]
  s_cselect_b32 s92, 0, 1
  s_cmp_eq_u32 s92, 1
  s_cbranch_scc1 L_jn
  buffer_store_dwordx2 v[200:201], v6, s[32:35], s62 offen sc1
  s_branch L_jd
L_jn:
  buffer_store_dwordx2 v[200:201], v6, s[32:35], s62 offen
L_jd:
  v_lshlrev_b32 v254, 4, v7
  s_lshl_b32 s62, s54, 14
  s_add_u32 s5, s62, 4096
  v_lshlrev_b32 v2, 2, v7
  s_mov_b32 s60, 2097152
  s_barrier
  s_branch L_qld
L_qpoll:
  s_sleep 8
L_qld:
  buffer_load_dwordx4 v[64:67], v254, s[32:35], s62 offen offset:0 sc1
  buffer_load_dwordx4 v[68:71], v254, s[32:35], s62 offen offset:1024 sc1
  buffer_load_dwordx4 v[72:75], v254, s[32:35], s62 offen offset:2048 sc1
  buffer_load_dwordx4 v[76:79], v254, s[32:35], s62 offen offset:3072 sc1
  buffer_load_dwordx4 v[80:83], v254, s[32:35], s5 offen offset:0 sc1
  buffer_load_dwordx4 v[84:87], v254, s[32:35], s5 offen offset:1024 sc1
  buffer_load_dwordx4 v[88:91], v254, s[32:35], s5 offen offset:2048 sc1
  buffer_load_dwordx4 v[92:95], v254, s[32:35], s5 offen offset:3072 sc1
  s_sub_u32 s60, s60, 1
  s_cbranch_scc1 L_qgo
  v_mov_b32 v24, s31
  v_mov_b32 v25, s31
  s_waitcnt vmcnt(0)
  v_min3_u32 v24, v24, v65, v67
  v_max3_u32 v25, v25, v65, v67
  v_min3_u32 v24, v24, v69, v71
  v_max3_u32 v25, v25, v69, v71
  v_min3_u32 v24, v24, v73, v75
  v_max3_u32 v25, v25, v73, v75
  v_min3_u32 v24, v24, v77, v79
  v_max3_u32 v25, v25, v77, v79
  v_min3_u32 v24, v24, v81, v83
  v_max3_u32 v25, v25, v81, v83
  v_min3_u32 v24, v24, v85, v87
  v_max3_u32 v25, v25, v85, v87
  v_min3_u32 v24, v24, v89, v91
  v_max3_u32 v25, v25, v89, v91
  v_min3_u32 v24, v24, v93, v95
  v_max3_u32 v25, v25, v93, v95
  v_cmp_ne_u32 vcc, v24, v25
  s_and_b64 exec, exec, vcc
  s_cbranch_scc1 L_qpoll
L_qgo:
  s_mov_b64 exec, -1
  v_add_f32 v64, v64, v80
  v_add_f32 v66, v66, v82
  v_add_f32 v68, v68, v84
  v_add_f32 v70, v70, v86
  v_add_f32 v72, v72, v88
  v_add_f32 v74, v74, v90
  v_add_f32 v76, v76, v92
  v_add_f32 v78, v78, v94
  v_cvt_pk_bf16_f32 v64, v64, v66
  v_cvt_pk_bf16_f32 v68, v68, v70
  v_cvt_pk_bf16_f32 v72, v72, v74
  v_cvt_pk_bf16_f32 v76, v76, v78
  ds_write_b32 v2, v64 offset:0
  ds_write_b32 v2, v68 offset:256
  ds_write_b32 v2, v72 offset:512
  ds_write_b32 v2, v76 offset:768
  s_waitcnt lgkmcnt(0)
  s_barrier
  buffer_load_dwordx2 v[28:29], v253, s[32:35], 0 offen sc1
  s_waitcnt vmcnt(0)
  v_cmp_ne_u32 vcc, s93, v28
  v_cmp_ne_u32 s[56:57], s30, v29
  s_or_b64 vcc, vcc, s[56:57]
  s_cselect_b32 s92, 0, 1
  s_mul_i32 s63, s92, 0x7fff0ff0
  s_lshl_b32 s74, s55, 6
  s_bitcmp1_b32 s63, s55
  s_cselect_b32 s74, s74, -1
  s_mov_b32 s40, s80
  s_mov_b32 s41, s81
  s_mov_b32 s42, 1605632
  s_mov_b32 s43, 0x20000
  s_movk_i32 s75, 768
  s_branch L_ctle
L_setup:
  ds_write_b32 v2, v2 offset:18496
  s_mov_b32 s101, 1
  v_mov_b32 v7, 0
  v_mov_b32 v6, 10240
  s_branch L_last
L_hret:
  v_and_b32 v7, 63, v0
  v_lshrrev_b32 v3, 3, v7
  v_and_b32 v4, 7, v7
  v_lshlrev_b32 v254, 4, v7
  buffer_load_dwordx4 v[32:35], v254, s[44:47], 0 offen
  s_mov_b64 s[44:45], s[82:83]
  buffer_load_dwordx4 v[36:39], v254, s[44:47], 0 offen
  s_mul_i32 s58, s98, 4224
  s_add_u32 s58, s58, 299008
  v_add_u32 v248, s58, v254
  v_lshrrev_b32 v1, 5, v7
  s_add_u32 s58, s58, 4096
  v_lshl_add_u32 v249, v1, 4, s58
  v_and_b32 v1, 3, v7
  v_lshl_add_u32 v249, v1, 5, v249
  v_cmp_gt_u32 vcc, 56, v7
  s_lshr_b32 s58, s98, 2
  s_lshl_b32 s58, s58, 6
  s_and_b32 s59, s55, 3
  s_lshl1_add_u32 s58, s59, s58
  s_mul_i32 s58, s58, 896
  v_add_u32 v5, s58, v254
  s_mul_i32 s58, s98, 7168
  v_add_u32 v6, s58, v254
  s_mul_i32 s58, s54, 135168
  s_add_u32 s58, s58, 299008
  v_mul_u32_u24 v1, 4224, v3
  v_add_u32 v1, s58, v1
  s_lshl_b32 s59, s59, 10
  s_lshr_b32 s58, s55, 2
  s_lshl_b32 s58, s58, 7
  s_add_u32 s59, s59, s58
  v_lshl_add_u32 v251, v4, 4, v1
  v_add_u32 v251, s59, v251
  s_and_b32 s59, s55, 16
  s_add_u32 s59, s59, 4096
  v_add_u32 v252, s59, v1
  v_mov_b32 v1, 1073741824
  v_cndmask_b32 v250, v1, v251, vcc
  v_cndmask_b32 v5, v1, v5, vcc
  v_cndmask_b32 v6, v1, v6, vcc
  v_lshlrev_b32 v255, 5, v7
  s_mov_b32 s48, s84
  s_mov_b32 s49, s85
  s_mov_b32 s50, 896
  s_mov_b32 s51, 0x20000
  s_waitcnt vmcnt(0)
  v_lshlrev_b32 v24, 16, v32
  v_and_b32 v25, 0xffff0000, v32
  v_lshlrev_b32 v32, 16, v36
  v_and_b32 v36, 0xffff0000, v36
  v_mul_f32 v24, v24, v32
  v_mul_f32 v25, v25, v36
  v_lshlrev_b32 v26, 16, v33
  v_and_b32 v27, 0xffff0000, v33
  v_lshlrev_b32 v33, 16, v37
  v_and_b32 v37, 0xffff0000, v37
  v_mul_f32 v26, v26, v33
  v_mul_f32 v27, v27, v37
  v_lshlrev_b32 v28, 16, v34
  v_and_b32 v29, 0xffff0000, v34
  v_lshlrev_b32 v34, 16, v38
  v_and_b32 v38, 0xffff0000, v38
  v_mul_f32 v28, v28, v34
  v_mul_f32 v29, v29, v38
  v_lshlrev_b32 v30, 16, v35
  v_and_b32 v31, 0xffff0000, v35
  v_lshlrev_b32 v35, 16, v39
  v_and_b32 v39, 0xffff0000, v39
  v_mul_f32 v30, v30, v35
  v_mul_f32 v31, v31, v39
  v_cvt_pk_bf16_f32 v24, v24, v24
  v_lshlrev_b32 v24, 16, v24
  v_cvt_pk_bf16_f32 v25, v25, v25
  v_lshlrev_b32 v25, 16, v25
  v_cvt_pk_bf16_f32 v26, v26, v26
  v_lshlrev_b32 v26, 16, v26
  v_cvt_pk_bf16_f32 v27, v27, v27
  v_lshlrev_b32 v27, 16, v27
  v_cvt_pk_bf16_f32 v28, v28, v28
  v_lshlrev_b32 v28, 16, v28
  v_cvt_pk_bf16_f32 v29, v29, v29
  v_lshlrev_b32 v29, 16, v29
  v_cvt_pk_bf16_f32 v30, v30, v30
  v_lshlrev_b32 v30, 16, v30
  v_cvt_pk_bf16_f32 v31, v31, v31
  v_lshlrev_b32 v31, 16, v31
  v_add_f32 v24, v24, v25
  v_add_f32 v24, v24, v26
  v_add_f32 v24, v24, v27
  v_add_f32 v24, v24, v28
  v_add_f32 v24, v24, v29
  v_add_f32 v24, v24, v30
  v_add_f32 v24, v24, v31
  s_nop 1
  v_add_f32_dpp v24, v24, v24 quad_perm:[1,0,3,2] row_mask:0xf bank_mask:0xf
  s_nop 1
  v_add_f32_dpp v24, v24, v24 quad_perm:[2,3,0,1] row_mask:0xf bank_mask:0xf
  s_nop 1
  v_add_f32_dpp v24, v24, v24 row_half_mirror row_mask:0xf bank_mask:0xf
  s_nop 1
  v_add_f32_dpp v24, v24, v24 row_mirror row_mask:0xf bank_mask:0xf
  v_mov_b32 v25, v24
  s_nop 1
  v_permlane16_swap_b32 v24, v25
  v_add_f32 v24, v24, v25
  v_mov_b32 v25, v24
  s_nop 1
  v_permlane32_swap_b32 v24, v25
  v_add_f32 v24, v24, v25
  v_cvt_pk_bf16_f32 v24, v24, v24
  v_lshlrev_b32 v24, 16, v24
  v_mul_f32 v24, 0xbfb8aa3b, v24
  v_exp_f32 v24, v24
  s_nop 0
  v_add_f32 v24, 1.0, v24
  v_rcp_f32 v24, v24
  s_nop 0
  v_cvt_pk_bf16_f32 v24, v24, v24
  v_lshlrev_b32 v24, 16, v24
  v_sub_f32 v25, 1.0, v24
  v_cvt_pk_bf16_f32 v25, v25, v25
  v_lshlrev_b32 v25, 16, v25
  v_readfirstlane_b32 s52, v24
  v_readfirstlane_b32 s53, v25
  s_mov_b32 s44, s72
  s_mov_b32 s45, s73
  s_mov_b32 s46, 3670016
  s_mov_b32 s47, 0x20000
  v_bfe_u32 v1, v7, 3, 1
  v_lshlrev_b32 v1, 12, v1
  v_lshrrev_b32 v2, 5, v7
  v_lshl_add_u32 v1, v2, 11, v1
  v_lshl_add_u32 v1, v4, 3, v1
  s_lshl_b32 s63, s55, 6
  s_add_u32 s62, s62, s63
  s_add_u32 s62, s62, 8192
  s_mov_b32 s60, 2097152
  s_branch L_fld
L_fpoll:
  s_sleep 8
L_fld:
  buffer_load_dwordx2 v[26:27], v1, s[32:35], s62 offen sc1
  s_sub_u32 s60, s60, 1
  s_cbranch_scc1 L_fgo
  s_waitcnt vmcnt(0)
  v_cmp_ne_u32 vcc, s31, v27
  s_and_b64 exec, exec, vcc
  s_cbranch_scc1 L_fpoll
L_fgo:
  s_mov_b64 exec, -1
  v_add_f32_dpp v24, v26, v26 row_ror:8 row_mask:0xf bank_mask:0xf
  v_cvt_pk_bf16_f32 v24, v24, v24
  v_lshlrev_b32 v24, 16, v24
  v_mov_b32 v25, v24
  s_nop 1
  v_permlane32_swap_b32 v24, v25
  v_mul_f32 v26, 0xbfb8aa3b, v24
  v_exp_f32 v26, v26
  s_nop 0
  v_add_f32 v26, 1.0, v26
  v_rcp_f32 v26, v26
  s_nop 0
  v_mul_f32 v24, v24, v26
  v_cvt_pk_bf16_f32 v24, v24, v24
  v_lshlrev_b32 v24, 16, v24
  v_mul_f32 v24, v24, v25
  v_cvt_pk_bf16_f32 v24, v24, v24
  v_lshlrev_b32 v24, 16, v24
  s_nop 0
  v_readlane_b32 s12, v24, 0
  v_readlane_b32 s13, v24, 1
  v_readlane_b32 s14, v24, 2
  v_readlane_b32 s15, v24, 3
  v_readlane_b32 s16, v24, 4
  v_readlane_b32 s17, v24, 5
  v_readlane_b32 s18, v24, 6
  v_readlane_b32 s19, v24, 7
  s_lshr_b32 s4, s12, 16
  s_lshr_b32 s5, s13, 16
  s_lshr_b32 s6, s14, 16
  s_lshr_b32 s7, s15, 16
  s_lshr_b32 s8, s16, 16
  s_lshr_b32 s9, s17, 16
  s_lshr_b32 s10, s18, 16
  s_lshr_b32 s11, s19, 16
  s_mov_b32 s61, 33792
  s_mov_b32 s62, 67584
  s_mov_b32 s63, 101376
  s_movk_i32 s20, 3584
  s_mov_b32 s21, 7168
  s_mov_b32 s22, 14336
  s_mov_b32 s23, 21504
  s_mov_b32 s24, 28672
  s_mov_b32 s25, 35840
  s_mov_b32 s26, 43008
  s_mov_b32 s27, 50176
  s_mov_b32 s70, 29568
  s_mov_b32 s71, 59136
  s_mov_b32 s72, 88704
  s_lshl_b32 s28, s55, 10
  s_add_u32 s28, s28, 266240
  s_lshl_b32 s29, s54, 7
  s_add_u32 s29, s29, s28
  s_mul_i32 s58, s55, 9363
  s_lshr_b32 s58, s58, 16
  s_mul_i32 s59, s58, 7
  s_sub_u32 s59, s55, s59
  s_lshl_b32 s59, s59, 7
  s_lshl2_add_u32 s73, s58, s59
  s_waitcnt vmcnt(0)
  s_mov_b32 s56, 0x05040100
  s_mov_b32 s57, 0x07060302
  s_mov_b32 s58, s42
  s_mov_b32 s59, s46
  s_mov_b32 s34, 0
  s_mov_b32 s42, 0
  s_mov_b32 s46, 0
  s_mov_b32 s50, 0
  s_mov_b32 s94, 0
  s_mov_b32 s31, 0
  s_mov_b32 s91, 0
  s_branch L_tail
L_real:
  s_waitcnt vmcnt(0)
  s_mov_b32 s34, 1662976
  s_mov_b32 s42, s58
  s_mov_b32 s46, s59
  s_movk_i32 s50, 896
  s_mov_b32 s94, 1
  s_mov_b32 s31, s30
  s_mov_b32 s91, s90
  s_mov_b32 s75, 2032
L_ctle:
  v_min_u32 v1, 33, v7
  v_lshlrev_b32 v1, 2, v1
  v_mov_b32 v2, 0
  s_mul_i32 s78, s55, 768
  s_add_u32 s78, s78, 1380352
  s_add_u32 s79, s99, 128
L_ctl:
  ds_read_b128 v[192:195], v2 offset:18512
  s_waitcnt lgkmcnt(0)
  v_add3_u32 v192, v192, v193, v194
  v_add_u32 v192, v192, v195
  s_mov_b64 exec, 1
  buffer_store_dword v192, off, s[32:35], s95
  s_mov_b64 exec, -1
  v_readfirstlane_b32 s76, v192
  s_cmp_ge_u32 s76, s75
  s_cbranch_scc1 L_ctlx
  buffer_load_dword v196, v1, s[32:35], s99 offen sc1
  s_add_i32 s76, s76, 0
  s_waitcnt vmcnt(0)
  v_readlane_b32 s81, v196, 32
  s_sub_i32 s76, s76, s81
  v_cmp_lt_u32 vcc, s76, v196
  s_bcnt1_i32_b32 s77, vcc_lo
  s_cmp_ge_i32 s77, 8
  s_cselect_b32 s77, s92, 0
  v_mov_b32 v197, s77
  ds_write_b32 v2, v197 offset:18496
  v_cmp_le_u32 vcc, s74, v196
  s_bcnt1_i32_b32 s77, vcc_lo
  s_cmp_ge_u32 s77, 16
  s_cbranch_scc0 L_ctl
  s_mov_b32 s77, 1
  s_atomic_add s77, s[88:89], s78 glc
  s_mov_b32 s74, -1
  s_waitcnt lgkmcnt(0)
  s_min_u32 s77, s77, 7
  s_lshl_b32 s77, s77, 1
  s_sub_i32 s77, s77, 7
  s_mul_i32 s77, s77, 5
  s_ashr_i32 s77, s77, 2
  v_mov_b32 v198, s77
  v_mov_b32 v199, s80
  s_mov_b64 exec, 1
  buffer_store_dwordx2 v[198:199], off, s[32:35], s79
  s_mov_b64 exec, -1
  s_branch L_ctl
L_ctlx:
  s_cmp_eq_u32 s75, 768
  s_cbranch_scc1 L_setup
  s_barrier
L_tail:
  buffer_load_dwordx4 v[32:35], v6, s[40:43], 0 offen offset:0 nt
  buffer_load_dwordx4 v[36:39], v6, s[40:43], 0 offen offset:896 nt
  buffer_load_dwordx4 v[40:43], v6, s[40:43], 0 offen offset:1792 nt
  buffer_load_dwordx4 v[44:47], v6, s[40:43], 0 offen offset:2688 nt
  buffer_load_dwordx4 v[48:51], v6, s[40:43], s20 offen offset:0 nt
  buffer_load_dwordx4 v[52:55], v6, s[40:43], s20 offen offset:896 nt
  buffer_load_dwordx4 v[56:59], v6, s[40:43], s20 offen offset:1792 nt
  buffer_load_dwordx4 v[60:63], v6, s[40:43], s20 offen offset:2688 nt
  buffer_load_dwordx4 v[64:67], v5, s[44:47], 0 offen offset:0 nt
  buffer_load_dwordx4 v[68:71], v5, s[44:47], 0 offen offset:896 nt
  buffer_load_dwordx4 v[72:75], v5, s[44:47], s21 offen offset:0 nt
  buffer_load_dwordx4 v[76:79], v5, s[44:47], s21 offen offset:896 nt
  buffer_load_dwordx4 v[80:83], v5, s[44:47], s22 offen offset:0 nt
  buffer_load_dwordx4 v[84:87], v5, s[44:47], s22 offen offset:896 nt
  buffer_load_dwordx4 v[88:91], v5, s[44:47], s23 offen offset:0 nt
  buffer_load_dwordx4 v[92:95], v5, s[44:47], s23 offen offset:896 nt
  buffer_load_dwordx4 v[96:99], v5, s[44:47], s24 offen offset:0 nt
  buffer_load_dwordx4 v[100:103], v5, s[44:47], s24 offen offset:896 nt
  buffer_load_dwordx4 v[104:107], v5, s[44:47], s25 offen offset:0 nt
  buffer_load_dwordx4 v[108:111], v5, s[44:47], s25 offen offset:896 nt
  buffer_load_dwordx4 v[112:115], v5, s[44:47], s26 offen offset:0 nt
  buffer_load_dwordx4 v[116:119], v5, s[44:47], s26 offen offset:896 nt
  buffer_load_dwordx4 v[120:123], v5, s[44:47], s27 offen offset:0 nt
  buffer_load_dwordx4 v[124:127], v5, s[44:47], s27 offen offset:896 nt
  v_mov_b32 v233, s30
  v_mov_b32 v235, s30
  v_mov_b32 v237, s30
  v_mov_b32 v239, s30
  v_mov_b32 v241, s30
  v_mov_b32 v243, s30
  v_mov_b32 v245, s30
  v_mov_b32 v247, s30
  v_mov_b32 v8, 0
  v_mov_b32 v9, 0
  v_mov_b32 v10, 0
  v_mov_b32 v11, 0
  v_mov_b32 v12, 0
  v_mov_b32 v13, 0
  v_mov_b32 v14, 0
  v_mov_b32 v15, 0
  v_mov_b32 v16, 0
  v_mov_b32 v17, 0
  v_mov_b32 v18, 0
  v_mov_b32 v19, 0
  v_mov_b32 v20, 0
  v_mov_b32 v21, 0
  v_mov_b32 v22, 0
  v_mov_b32 v23, 0
  v_mov_b32 v25, s30
  v_mov_b32 v27, s30
  v_and_b32 v1, 32, v7
  s_mov_b32 s60, 2097152
  s_cmp_eq_u32 s94, 0
  s_cbranch_scc1 L_nb2
  s_barrier
L_nb2:
  ds_read_b128 v[224:227], v1 offset:18432
  ds_read_b128 v[228:231], v1 offset:18448
  ds_read_b128 v[192:195], v255 offset:10240
  ds_read_b128 v[196:199], v255 offset:10256
  ds_read_b128 v[200:203], v255 offset:12288
  ds_read_b128 v[204:207], v255 offset:12304
  ds_read_b128 v[208:211], v255 offset:14336
  ds_read_b128 v[212:215], v255 offset:14352
  ds_read_b128 v[216:219], v255 offset:16384
  ds_read_b128 v[220:223], v255 offset:16400
  s_waitcnt lgkmcnt(8)
  v_max3_f32 v24, v224, v226, v228
  v_max_f32 v24, v24, v230
  v_sub_f32 v224, v224, v24
  v_sub_f32 v226, v226, v24
  v_sub_f32 v228, v228, v24
  v_sub_f32 v230, v230, v24
  v_exp_f32 v224, v224
  v_exp_f32 v226, v226
  v_exp_f32 v228, v228
  v_exp_f32 v230, v230
  v_mul_f32 v26, v224, v225
  v_fmac_f32 v26, v226, v227
  v_fmac_f32 v26, v228, v229
  v_fmac_f32 v26, v230, v231
  s_waitcnt lgkmcnt(0)
  v_pk_mul_f32 v[192:193], v[192:193], v[224:225] op_sel_hi:[1,0]
  v_pk_mul_f32 v[194:195], v[194:195], v[224:225] op_sel_hi:[1,0]
  v_pk_mul_f32 v[196:197], v[196:197], v[224:225] op_sel_hi:[1,0]
  v_pk_mul_f32 v[198:199], v[198:199], v[224:225] op_sel_hi:[1,0]
  v_pk_fma_f32 v[192:193], v[200:201], v[226:227], v[192:193] op_sel_hi:[1,0,1]
  v_pk_fma_f32 v[194:195], v[202:203], v[226:227], v[194:195] op_sel_hi:[1,0,1]
  v_pk_fma_f32 v[196:197], v[204:205], v[226:227], v[196:197] op_sel_hi:[1,0,1]
  v_pk_fma_f32 v[198:199], v[206:207], v[226:227], v[198:199] op_sel_hi:[1,0,1]
  v_pk_fma_f32 v[192:193], v[208:209], v[228:229], v[192:193] op_sel_hi:[1,0,1]
  v_pk_fma_f32 v[194:195], v[210:211], v[228:229], v[194:195] op_sel_hi:[1,0,1]
  v_pk_fma_f32 v[196:197], v[212:213], v[228:229], v[196:197] op_sel_hi:[1,0,1]
  v_pk_fma_f32 v[198:199], v[214:215], v[228:229], v[198:199] op_sel_hi:[1,0,1]
  v_fma_f32 v232, v216, v230, v192
  v_fma_f32 v234, v217, v230, v193
  v_fma_f32 v236, v218, v230, v194
  v_fma_f32 v238, v219, v230, v195
  v_fma_f32 v240, v220, v230, v196
  v_fma_f32 v242, v221, v230, v197
  v_fma_f32 v244, v222, v230, v198
  v_fma_f32 v246, v223, v230, v199
  s_cmp_eq_u32 s92, 1
  s_cbranch_scc1 L_p1n
  buffer_store_dwordx4 v[232:235], v248, s[32:35], 0 offen offset:0 sc1
  buffer_store_dwordx4 v[236:239], v248, s[32:35], 0 offen offset:1024 sc1
  buffer_store_dwordx4 v[240:243], v248, s[32:35], 0 offen offset:2048 sc1
  buffer_store_dwordx4 v[244:247], v248, s[32:35], 0 offen offset:3072 sc1
  buffer_store_dwordx4 v[24:27], v249, s[32:35], 0 offen sc1
  s_branch L_p1d
L_p1n:
  buffer_store_dwordx4 v[232:235], v248, s[32:35], 0 offen offset:0
  buffer_store_dwordx4 v[236:239], v248, s[32:35], 0 offen offset:1024
  buffer_store_dwordx4 v[240:243], v248, s[32:35], 0 offen offset:2048
  buffer_store_dwordx4 v[244:247], v248, s[32:35], 0 offen offset:3072
  buffer_store_dwordx4 v[24:27], v249, s[32:35], 0 offen
L_p1d:
  buffer_load_dwordx4 v[208:211], v252, s[32:35], 0 offen sc1
  buffer_load_dwordx4 v[192:195], v251, s[32:35], 0 offen sc1
  buffer_load_dwordx4 v[212:215], v252, s[32:35], s61 offen sc1
  buffer_load_dwordx4 v[196:199], v251, s[32:35], s61 offen sc1
  buffer_load_dwordx4 v[216:219], v252, s[32:35], s62 offen sc1
  buffer_load_dwordx4 v[200:203], v251, s[32:35], s62 offen sc1
  buffer_load_dwordx4 v[220:223], v252, s[32:35], s63 offen sc1
  buffer_load_dwordx4 v[204:207], v251, s[32:35], s63 offen sc1
  v_mov_b32 v233, s90
  v_mov_b32 v235, s90
  v_mov_b32 v237, s90
  v_mov_b32 v239, s90
  v_mov_b32 v241, s90
  v_mov_b32 v243, s90
  v_mov_b32 v245, s90
  v_mov_b32 v247, s90
  s_waitcnt vmcnt(35)
  v_dot2c_f32_bf16 v8, s4, v32
  v_dot2c_f32_bf16 v9, s12, v32
  v_dot2c_f32_bf16 v10, s4, v33
  v_dot2c_f32_bf16 v11, s12, v33
  v_dot2c_f32_bf16 v12, s4, v34
  v_dot2c_f32_bf16 v13, s12, v34
  v_dot2c_f32_bf16 v14, s4, v35
  v_dot2c_f32_bf16 v15, s12, v35
  v_dot2c_f32_bf16 v8, s5, v36
  v_dot2c_f32_bf16 v9, s13, v36
  v_dot2c_f32_bf16 v10, s5, v37
  v_dot2c_f32_bf16 v11, s13, v37
  v_dot2c_f32_bf16 v12, s5, v38
  v_dot2c_f32_bf16 v13, s13, v38
  v_dot2c_f32_bf16 v14, s5, v39
  v_dot2c_f32_bf16 v15, s13, v39
  s_waitcnt vmcnt(33)
  v_dot2c_f32_bf16 v8, s6, v40
  v_dot2c_f32_bf16 v9, s14, v40
  v_dot2c_f32_bf16 v10, s6, v41
  v_dot2c_f32_bf16 v11, s14, v41
  v_dot2c_f32_bf16 v12, s6, v42
  v_dot2c_f32_bf16 v13, s14, v42
  v_dot2c_f32_bf16 v14, s6, v43
  v_dot2c_f32_bf16 v15, s14, v43
  v_dot2c_f32_bf16 v8, s7, v44
  v_dot2c_f32_bf16 v9, s15, v44
  v_dot2c_f32_bf16 v10, s7, v45
  v_dot2c_f32_bf16 v11, s15, v45
  v_dot2c_f32_bf16 v12, s7, v46
  v_dot2c_f32_bf16 v13, s15, v46
  v_dot2c_f32_bf16 v14, s7, v47
  v_dot2c_f32_bf16 v15, s15, v47
  s_waitcnt vmcnt(31)
  v_dot2c_f32_bf16 v8, s8, v48
  v_dot2c_f32_bf16 v9, s16, v48
  v_dot2c_f32_bf16 v10, s8, v49
  v_dot2c_f32_bf16 v11, s16, v49
  v_dot2c_f32_bf16 v12, s8, v50
  v_dot2c_f32_bf16 v13, s16, v50
  v_dot2c_f32_bf16 v14, s8, v51
  v_dot2c_f32_bf16 v15, s16, v51
  v_dot2c_f32_bf16 v8, s9, v52
  v_dot2c_f32_bf16 v9, s17, v52
  v_dot2c_f32_bf16 v10, s9, v53
  v_dot2c_f32_bf16 v11, s17, v53
  v_dot2c_f32_bf16 v12, s9, v54
  v_dot2c_f32_bf16 v13, s17, v54
  v_dot2c_f32_bf16 v14, s9, v55
  v_dot2c_f32_bf16 v15, s17, v55
  s_waitcnt vmcnt(29)
  v_dot2c_f32_bf16 v8, s10, v56
  v_dot2c_f32_bf16 v9, s18, v56
  v_dot2c_f32_bf16 v10, s10, v57
  v_dot2c_f32_bf16 v11, s18, v57
  v_dot2c_f32_bf16 v12, s10, v58
  v_dot2c_f32_bf16 v13, s18, v58
  v_dot2c_f32_bf16 v14, s10, v59
  v_dot2c_f32_bf16 v15, s18, v59
  v_dot2c_f32_bf16 v8, s11, v60
  v_dot2c_f32_bf16 v9, s19, v60
  v_dot2c_f32_bf16 v10, s11, v61
  v_dot2c_f32_bf16 v11, s19, v61
  v_dot2c_f32_bf16 v12, s11, v62
  v_dot2c_f32_bf16 v13, s19, v62
  v_dot2c_f32_bf16 v14, s11, v63
  v_dot2c_f32_bf16 v15, s19, v63
  s_waitcnt vmcnt(27)
  v_perm_b32 v128, v68, v64, s56
  v_perm_b32 v129, v68, v64, s57
  v_perm_b32 v130, v69, v65, s56
  v_perm_b32 v131, v69, v65, s57
  v_perm_b32 v132, v70, v66, s56
  v_perm_b32 v133, v70, v66, s57
  v_perm_b32 v134, v71, v67, s56
  v_perm_b32 v135, v71, v67, s57
  v_mul_f32 v8, s53, v8
  s_waitcnt vmcnt(25)
  v_perm_b32 v136, v76, v72, s56
  v_perm_b32 v137, v76, v72, s57
  v_perm_b32 v138, v77, v73, s56
  v_perm_b32 v139, v77, v73, s57
  v_perm_b32 v140, v78, v74, s56
  v_perm_b32 v141, v78, v74, s57
  v_perm_b32 v142, v79, v75, s56
  v_perm_b32 v143, v79, v75, s57
  v_mul_f32 v9, s53, v9
  s_waitcnt vmcnt(23)
  v_perm_b32 v144, v84, v80, s56
  v_perm_b32 v145, v84, v80, s57
  v_perm_b32 v146, v85, v81, s56
  v_perm_b32 v147, v85, v81, s57
  v_perm_b32 v148, v86, v82, s56
  v_perm_b32 v149, v86, v82, s57
  v_perm_b32 v150, v87, v83, s56
  v_perm_b32 v151, v87, v83, s57
  v_mul_f32 v10, s53, v10
  s_waitcnt vmcnt(21)
  v_perm_b32 v152, v92, v88, s56
  v_perm_b32 v153, v92, v88, s57
  v_perm_b32 v154, v93, v89, s56
  v_perm_b32 v155, v93, v89, s57
  v_perm_b32 v156, v94, v90, s56
  v_perm_b32 v157, v94, v90, s57
  v_perm_b32 v158, v95, v91, s56
  v_perm_b32 v159, v95, v91, s57
  v_mul_f32 v11, s53, v11
  s_waitcnt vmcnt(19)
  v_perm_b32 v160, v100, v96, s56
  v_perm_b32 v161, v100, v96, s57
  v_perm_b32 v162, v101, v97, s56
  v_perm_b32 v163, v101, v97, s57
  v_perm_b32 v164, v102, v98, s56
  v_perm_b32 v165, v102, v98, s57
  v_perm_b32 v166, v103, v99, s56
  v_perm_b32 v167, v103, v99, s57
  v_mul_f32 v12, s53, v12
  s_waitcnt vmcnt(17)
  v_perm_b32 v168, v108, v104, s56
  v_perm_b32 v169, v108, v104, s57
  v_perm_b32 v170, v109, v105, s56
  v_perm_b32 v171, v109, v105, s57
  v_perm_b32 v172, v110, v106, s56
  v_perm_b32 v173, v110, v106, s57
  v_perm_b32 v174, v111, v107, s56
  v_perm_b32 v175, v111, v107, s57
  v_mul_f32 v13, s53, v13
  s_waitcnt vmcnt(15)
  v_perm_b32 v176, v116, v112, s56
  v_perm_b32 v177, v116, v112, s57
  v_perm_b32 v178, v117, v113, s56
  v_perm_b32 v179, v117, v113, s57
  v_perm_b32 v180, v118, v114, s56
  v_perm_b32 v181, v118, v114, s57
  v_perm_b32 v182, v119, v115, s56
  v_perm_b32 v183, v119, v115, s57
  v_mul_f32 v14, s53, v14
  s_waitcnt vmcnt(13)
  v_perm_b32 v184, v124, v120, s56
  v_perm_b32 v185, v124, v120, s57
  v_perm_b32 v186, v125, v121, s56
  v_perm_b32 v187, v125, v121, s57
  v_perm_b32 v188, v126, v122, s56
  v_perm_b32 v189, v126, v122, s57
  v_perm_b32 v190, v127, v123, s56
  v_perm_b32 v191, v127, v123, s57
  v_mul_f32 v15, s53, v15
  s_branch L_g1c
L_g1:
  buffer_load_dwordx4 v[208:211], v252, s[32:35], 0 offen sc1
  buffer_load_dwordx4 v[192:195], v251, s[32:35], 0 offen sc1
  buffer_load_dwordx4 v[212:215], v252, s[32:35], s61 offen sc1
  buffer_load_dwordx4 v[196:199], v251, s[32:35], s61 offen sc1
  buffer_load_dwordx4 v[216:219], v252, s[32:35], s62 offen sc1
  buffer_load_dwordx4 v[200:203], v251, s[32:35], s62 offen sc1
  buffer_load_dwordx4 v[220:223], v252, s[32:35], s63 offen sc1
  buffer_load_dwordx4 v[204:207], v251, s[32:35], s63 offen sc1
  s_sub_u32 s60, s60, 1
  s_cbranch_scc1 L_g1x
L_g1c:
  v_mov_b32 v28, s31
  v_mov_b32 v29, s31
  s_waitcnt vmcnt(0)
  v_min3_u32 v28, v28, v193, v195
  v_max3_u32 v29, v29, v193, v195
  v_min3_u32 v28, v28, v197, v199
  v_max3_u32 v29, v29, v197, v199
  v_min3_u32 v28, v28, v201, v203
  v_max3_u32 v29, v29, v201, v203
  v_min3_u32 v28, v28, v205, v207
  v_max3_u32 v29, v29, v205, v207
  v_min3_u32 v28, v28, v209, v211
  v_max3_u32 v29, v29, v209, v211
  v_min3_u32 v28, v28, v213, v215
  v_max3_u32 v29, v29, v213, v215
  v_min3_u32 v28, v28, v217, v219
  v_max3_u32 v29, v29, v217, v219
  v_min3_u32 v28, v28, v221, v223
  v_max3_u32 v29, v29, v221, v223
  v_cmp_ne_u32 vcc, v28, v29
  s_and_b64 exec, exec, vcc
  s_cbranch_scc1 L_g1
L_g1x:
  s_mov_b64 exec, -1
  v_max3_f32 v28, v208, v212, v216
  v_max_f32 v28, v28, v220
  s_nop 1
  v_max_f32_dpp v28, v28, v28 row_ror:8 row_mask:0xf bank_mask:0xf
  v_mov_b32 v29, v28
  s_nop 1
  v_permlane16_swap_b32 v28, v29
  v_max_f32 v28, v28, v29
  v_mov_b32 v29, v28
  s_nop 1
  v_permlane32_swap_b32 v28, v29
  v_max_f32 v28, v28, v29
  v_sub_f32 v208, v208, v28
  v_sub_f32 v212, v212, v28
  v_sub_f32 v216, v216, v28
  v_sub_f32 v220, v220, v28
  v_exp_f32 v208, v208
  v_exp_f32 v212, v212
  v_exp_f32 v216, v216
  v_exp_f32 v220, v220
  v_mul_f32 v224, v208, v192
  v_mul_f32 v225, v208, v194
  v_mul_f32 v226, v208, v210
  v_fmac_f32 v224, v212, v196
  v_fmac_f32 v225, v212, v198
  v_fmac_f32 v226, v212, v214
  v_fmac_f32 v224, v216, v200
  v_fmac_f32 v225, v216, v202
  v_fmac_f32 v226, v216, v218
  v_fmac_f32 v224, v220, v204
  v_fmac_f32 v225, v220, v206
  v_fmac_f32 v226, v220, v222
  v_add_f32_dpp v224, v224, v224 row_ror:8 row_mask:0xf bank_mask:0xf
  v_add_f32_dpp v225, v225, v225 row_ror:8 row_mask:0xf bank_mask:0xf
  v_add_f32_dpp v226, v226, v226 row_ror:8 row_mask:0xf bank_mask:0xf
  v_mov_b32 v227, v224
  v_mov_b32 v228, v225
  v_mov_b32 v229, v226
  v_permlane16_swap_b32 v224, v227
  v_permlane16_swap_b32 v225, v228
  v_permlane16_swap_b32 v226, v229
  v_add_f32 v226, v226, v229
  v_add_f32 v224, v224, v227
  v_add_f32 v225, v225, v228
  v_mov_b32 v227, v224
  v_mov_b32 v228, v225
  v_mov_b32 v229, v226
  v_permlane32_swap_b32 v224, v227
  v_permlane32_swap_b32 v225, v228
  v_permlane32_swap_b32 v226, v229
  v_add_f32 v226, v226, v229
  v_add_f32 v224, v224, v227
  v_add_f32 v225, v225, v228
  v_rcp_f32 v226, v226
  s_nop 0
  v_mul_f32 v224, v224, v226
  v_mul_f32 v225, v225, v226
  v_cvt_pk_bf16_f32 v224, v224, v225
  s_nop 0
  v_readlane_b32 s76, v224, 0
  v_readlane_b32 s77, v224, 1
  v_readlane_b32 s78, v224, 2
  v_readlane_b32 s79, v224, 3
  v_readlane_b32 s80, v224, 4
  v_readlane_b32 s81, v224, 5
  v_readlane_b32 s82, v224, 6
  v_readlane_b32 s83, v224, 7
  v_dot2c_f32_bf16 v16, s76, v128
  v_dot2c_f32_bf16 v17, s76, v129
  v_dot2c_f32_bf16 v18, s76, v130
  v_dot2c_f32_bf16 v19, s76, v131
  v_dot2c_f32_bf16 v20, s76, v132
  v_dot2c_f32_bf16 v21, s76, v133
  v_dot2c_f32_bf16 v22, s76, v134
  v_dot2c_f32_bf16 v23, s76, v135
  v_dot2c_f32_bf16 v16, s77, v136
  v_dot2c_f32_bf16 v17, s77, v137
  v_dot2c_f32_bf16 v18, s77, v138
  v_dot2c_f32_bf16 v19, s77, v139
  v_dot2c_f32_bf16 v20, s77, v140
  v_dot2c_f32_bf16 v21, s77, v141
  v_dot2c_f32_bf16 v22, s77, v142
  v_dot2c_f32_bf16 v23, s77, v143
  v_dot2c_f32_bf16 v16, s78, v144
  v_dot2c_f32_bf16 v17, s78, v145
  v_dot2c_f32_bf16 v18, s78, v146
  v_dot2c_f32_bf16 v19, s78, v147
  v_dot2c_f32_bf16 v20, s78, v148
  v_dot2c_f32_bf16 v21, s78, v149
  v_dot2c_f32_bf16 v22, s78, v150
  v_dot2c_f32_bf16 v23, s78, v151
  v_dot2c_f32_bf16 v16, s79, v152
  v_dot2c_f32_bf16 v17, s79, v153
  v_dot2c_f32_bf16 v18, s79, v154
  v_dot2c_f32_bf16 v19, s79, v155
  v_dot2c_f32_bf16 v20, s79, v156
  v_dot2c_f32_bf16 v21, s79, v157
  v_dot2c_f32_bf16 v22, s79, v158
  v_dot2c_f32_bf16 v23, s79, v159
  v_dot2c_f32_bf16 v16, s80, v160
  v_dot2c_f32_bf16 v17, s80, v161
  v_dot2c_f32_bf16 v18, s80, v162
  v_dot2c_f32_bf16 v19, s80, v163
  v_dot2c_f32_bf16 v20, s80, v164
  v_dot2c_f32_bf16 v21, s80, v165
  v_dot2c_f32_bf16 v22, s80, v166
  v_dot2c_f32_bf16 v23, s80, v167
  v_dot2c_f32_bf16 v16, s81, v168
  v_dot2c_f32_bf16 v17, s81, v169
  v_dot2c_f32_bf16 v18, s81, v170
  v_dot2c_f32_bf16 v19, s81, v171
  v_dot2c_f32_bf16 v20, s81, v172
  v_dot2c_f32_bf16 v21, s81, v173
  v_dot2c_f32_bf16 v22, s81, v174
  v_dot2c_f32_bf16 v23, s81, v175
  v_dot2c_f32_bf16 v16, s82, v176
  v_dot2c_f32_bf16 v17, s82, v177
  v_dot2c_f32_bf16 v18, s82, v178
  v_dot2c_f32_bf16 v19, s82, v179
  v_dot2c_f32_bf16 v20, s82, v180
  v_dot2c_f32_bf16 v21, s82, v181
  v_dot2c_f32_bf16 v22, s82, v182
  v_dot2c_f32_bf16 v23, s82, v183
  v_dot2c_f32_bf16 v16, s83, v184
  v_dot2c_f32_bf16 v17, s83, v185
  v_dot2c_f32_bf16 v18, s83, v186
  v_dot2c_f32_bf16 v19, s83, v187
  v_dot2c_f32_bf16 v20, s83, v188
  v_dot2c_f32_bf16 v21, s83, v189
  v_dot2c_f32_bf16 v22, s83, v190
  v_dot2c_f32_bf16 v23, s83, v191
  v_fma_f32 v232, v16, s52, v8
  v_fma_f32 v234, v17, s52, v9
  v_fma_f32 v236, v18, s52, v10
  v_fma_f32 v238, v19, s52, v11
  v_fma_f32 v240, v20, s52, v12
  v_fma_f32 v242, v21, s52, v13
  v_fma_f32 v244, v22, s52, v14
  v_fma_f32 v246, v23, s52, v15
  s_cmp_eq_u32 s92, 1
  s_cbranch_scc1 L_p2n
  buffer_store_dwordx4 v[232:235], v250, s[32:35], 0 offen sc1
  buffer_store_dwordx4 v[236:239], v250, s[32:35], s70 offen sc1
  buffer_store_dwordx4 v[240:243], v250, s[32:35], s71 offen sc1
  buffer_store_dwordx4 v[244:247], v250, s[32:35], s72 offen sc1
  s_branch L_p2d
L_p2n:
  buffer_store_dwordx4 v[232:235], v250, s[32:35], 0 offen
  buffer_store_dwordx4 v[236:239], v250, s[32:35], s70 offen
  buffer_store_dwordx4 v[240:243], v250, s[32:35], s71 offen
  buffer_store_dwordx4 v[244:247], v250, s[32:35], s72 offen
L_p2d:
  s_mov_b32 s60, 2097152
  s_cmp_ge_u32 s55, 28
  s_cbranch_scc1 L_fin
L_g2:
  buffer_load_dwordx4 v[192:195], v248, s[32:35], 0 offen offset:0 sc1
  buffer_load_dwordx4 v[196:199], v248, s[32:35], 0 offen offset:1024 sc1
  buffer_load_dwordx4 v[200:203], v248, s[32:35], 0 offen offset:2048 sc1
  buffer_load_dwordx4 v[204:207], v248, s[32:35], 0 offen offset:3072 sc1
  s_sub_u32 s60, s60, 1
  s_cbranch_scc1 L_g2x
  v_mov_b32 v28, s91
  v_mov_b32 v29, s91
  s_waitcnt vmcnt(0)
  v_min3_u32 v28, v28, v193, v195
  v_max3_u32 v29, v29, v193, v195
  v_min3_u32 v28, v28, v197, v199
  v_max3_u32 v29, v29, v197, v199
  v_min3_u32 v28, v28, v201, v203
  v_max3_u32 v29, v29, v201, v203
  v_min3_u32 v28, v28, v205, v207
  v_max3_u32 v29, v29, v205, v207
  v_cmp_ne_u32 vcc, v28, v29
  s_and_b64 exec, exec, vcc
  s_cbranch_scc1 L_g2
L_g2x:
  s_mov_b64 exec, -1
  v_add_f32 v192, v192, v200
  v_add_f32 v194, v194, v202
  v_add_f32 v196, v196, v204
  v_add_f32 v198, v198, v206
  v_add_f32 v192, v192, v196
  v_add_f32 v194, v194, v198
  s_nop 0
  v_add_f32_dpp v192, v192, v192 row_ror:8 row_mask:0xf bank_mask:0xf
  v_add_f32_dpp v194, v194, v194 row_ror:8 row_mask:0xf bank_mask:0xf
  v_mov_b32 v193, v192
  v_mov_b32 v195, v194
  s_nop 0
  v_permlane16_swap_b32 v192, v193
  v_permlane16_swap_b32 v194, v195
  v_add_f32 v192, v192, v193
  v_add_f32 v194, v194, v195
  v_mov_b32 v193, v192
  v_mov_b32 v195, v194
  s_nop 0
  v_permlane32_swap_b32 v192, v193
  v_permlane32_swap_b32 v194, v195
  v_add_f32 v24, v192, v193
  v_add_f32 v26, v194, v195
  s_mov_b64 exec, 0xff
  buffer_store_dwordx4 v[24:27], v254, s[32:35], s29 offen sc1
  s_mov_b64 exec, -1
  s_mov_b32 s60, 2097152
  s_and_b32 s76, s55, 7
  s_cmp_eq_u32 s76, s54
  s_cbranch_scc0 L_fin
L_g3:
  buffer_load_dwordx4 v[192:195], v254, s[32:35], s28 offen sc1
  s_sub_u32 s60, s60, 1
  s_cbranch_scc1 L_g3x
  v_mov_b32 v28, s31
  v_mov_b32 v29, s31
  s_waitcnt vmcnt(0)
  v_min3_u32 v28, v28, v193, v195
  v_max3_u32 v29, v29, v193, v195
  v_cmp_ne_u32 vcc, v28, v29
  s_and_b64 exec, exec, vcc
  s_cbranch_scc1 L_g3
L_g3x:
  s_mov_b64 exec, -1
  v_add_f32_dpp v192, v192, v192 row_ror:8 row_mask:0xf bank_mask:0xf
  v_add_f32_dpp v194, v194, v194 row_ror:8 row_mask:0xf bank_mask:0xf
  v_mov_b32 v193, v192
  v_mov_b32 v195, v194
  s_nop 0
  v_permlane16_swap_b32 v192, v193
  v_permlane16_swap_b32 v194, v195
  v_add_f32 v192, v192, v193
  v_add_f32 v194, v194, v195
  v_mov_b32 v193, v192
  v_mov_b32 v195, v194
  s_nop 0
  v_permlane32_swap_b32 v192, v193
  v_permlane32_swap_b32 v194, v195
  v_add_f32 v192, v192, v193
  v_add_f32 v194, v194, v195
  v_cvt_pk_bf16_f32 v192, v192, v194
  s_mov_b64 exec, 0xff
  buffer_store_dword v192, v254, s[48:51], s73 offen
  s_mov_b64 exec, -1
  s_cmp_eq_u32 s2, 0
  s_cbranch_scc0 L_fin
  s_mov_b32 s76, 262144
  buffer_store_dword v233, off, s[32:35], s76
L_fin:
  s_cmp_eq_u32 s94, 0
  s_cbranch_scc1 L_real
L_end:
  s_endpgm
L_spro:
  s_mov_b32 s101, 0
  s_add_u32 s12, s68, s22
  s_addc_u32 s13, s69, 0
  v_and_b32 v11, 15, v7
  v_lshlrev_b32 v12, 4, v11
  v_bfe_u32 v13, v7, 4, 1
  v_lshl_add_u32 v12, v13, 9, v12
  v_bfe_u32 v13, v7, 5, 1
  v_lshl_add_u32 v12, v13, 12, v12
  v_add_u32 v2, s29, v12
  v_bfe_u32 v13, v7, 2, 1
  v_lshl_add_u32 v52, v13, 9, v9
  v_lshlrev_b32 v12, 4, v13
  v_lshl_add_u32 v12, v8, 5, v12
  s_mul_i32 s23, s3, 2176
  s_add_u32 s23, s23, 1024
  v_add_u32 v3, s23, v12
  v_mov_b32 v4, 0xff800000
  v_mov_b32 v5, 0
  v_mov_b32 v24, v4
  v_mov_b32 v25, v4
  v_mov_b32 v26, v4
  v_mov_b32 v27, v4
  v_mov_b32 v28, v4
  v_mov_b32 v29, v4
  v_mov_b32 v30, v4
  v_mov_b32 v31, v4
  v_mov_b32 v32, v4
  v_mov_b32 v33, v4
  v_mov_b32 v34, v4
  v_mov_b32 v35, v4
  v_and_b32 v12, 1, v8
  v_lshlrev_b32 v12, 10, v12
  v_lshrrev_b32 v13, 1, v8
  v_lshl_add_u32 v12, v13, 9, v12
  v_lshl_add_u32 v12, v11, 5, v12
  s_lshl_b32 s23, s3, 11
  s_add_u32 s23, s23, 10240
  v_add_u32 v6, s23, v12
  s_lshl_b32 s23, s3, 3
  v_lshl_add_u32 v7, v7, 3, s23
  s_mov_b32 s18, 0x05040100
  s_mov_b32 s19, 0x07060302
  s_mov_b32 s20, 0x3db8aa3b
  s_mov_b32 s24, 0x00110011
  s_mov_b32 s25, s24
  s_mov_b32 s26, 0
  s_mov_b32 s27, -1
  s_mov_b32 s17, 0
  s_mov_b64 vcc, 0
  v_mov_b32 v60, 0
  ds_write_b32 v60, v60 offset:18496
  s_mov_b32 s30, 0
  v_mov_b32 v62, 0
  v_mov_b32 v61, 48
  s_lshl_b32 s23, s3, 2
  v_mov_b32 v63, s23
  ds_write_b32 v63, v61 offset:18512
  s_waitcnt vmcnt(4)
  buffer_load_dwordx4 v[212:215], v1, s[8:11], s16 offen offset:256 nt
  s_waitcnt vmcnt(4)
  buffer_load_dwordx4 v[216:219], v1, s[8:11], s16 offen offset:1024 nt
  s_waitcnt vmcnt(4)
  buffer_load_dwordx4 v[220:223], v1, s[8:11], s16 offen offset:1280 nt
  s_add_u32 s16, s16, s28
  s_waitcnt vmcnt(4)
  buffer_load_dwordx4 v[224:227], v1, s[8:11], s16 offen offset:0 nt
  s_waitcnt vmcnt(4)
  buffer_load_dwordx4 v[228:231], v1, s[8:11], s16 offen offset:256 nt
  s_waitcnt vmcnt(4)
  buffer_load_dwordx4 v[232:235], v1, s[8:11], s16 offen offset:1024 nt
  s_waitcnt vmcnt(4)
  buffer_load_dwordx4 v[236:239], v1, s[8:11], s16 offen offset:1280 nt
  s_add_u32 s16, s16, s28
  s_waitcnt vmcnt(4)
  buffer_load_dwordx4 v[240:243], v1, s[8:11], s16 offen offset:0 nt
  s_waitcnt vmcnt(4)
  buffer_load_dwordx4 v[244:247], v1, s[8:11], s16 offen offset:256 nt
  s_waitcnt vmcnt(4)
  buffer_load_dwordx4 v[248:251], v1, s[8:11], s16 offen offset:1024 nt
  s_waitcnt vmcnt(4)
  buffer_load_dwordx4 v[252:255], v1, s[8:11], s16 offen offset:1280 nt
  s_add_u32 s16, s16, s28
  s_waitcnt vmcnt(4)
  buffer_load_dwordx4 v[64:67], v1, s[8:11], s16 offen offset:0 nt
  s_waitcnt vmcnt(4)
  buffer_load_dwordx4 v[68:71], v1, s[8:11], s16 offen offset:256 nt
  s_waitcnt vmcnt(4)
  buffer_load_dwordx4 v[72:75], v1, s[8:11], s16 offen offset:1024 nt
  s_waitcnt vmcnt(4)
  buffer_load_dwordx4 v[76:79], v1, s[8:11], s16 offen offset:1280 nt
  s_add_u32 s16, s16, s28
  s_waitcnt vmcnt(4)
  buffer_load_dwordx4 v[80:83], v1, s[8:11], s16 offen offset:0 nt
  s_waitcnt vmcnt(4)
  buffer_load_dwordx4 v[84:87], v1, s[8:11], s16 offen offset:256 nt
  s_waitcnt vmcnt(4)
  buffer_load_dwordx4 v[88:91], v1, s[8:11], s16 offen offset:1024 nt
  s_waitcnt vmcnt(4)
  buffer_load_dwordx4 v[92:95], v1, s[8:11], s16 offen offset:1280 nt
  s_add_u32 s16, s16, s28
  s_waitcnt vmcnt(4)
  buffer_load_dwordx4 v[96:99], v1, s[8:11], s16 offen offset:0 nt
  s_waitcnt vmcnt(4)
  buffer_load_dwordx4 v[100:103], v1, s[8:11], s16 offen offset:256 nt
  s_waitcnt vmcnt(4)
  buffer_load_dwordx4 v[104:107], v1, s[8:11], s16 offen offset:1024 nt
  s_waitcnt vmcnt(4)
  buffer_load_dwordx4 v[108:111], v1, s[8:11], s16 offen offset:1280 nt
  s_add_u32 s16, s16, s28
  s_waitcnt vmcnt(4)
  buffer_load_dwordx4 v[112:115], v1, s[8:11], s16 offen offset:0 nt
  s_waitcnt vmcnt(4)
  buffer_load_dwordx4 v[116:119], v1, s[8:11], s16 offen offset:256 nt
  s_waitcnt vmcnt(4)
  buffer_load_dwordx4 v[120:123], v1, s[8:11], s16 offen offset:1024 nt
  s_waitcnt vmcnt(4)
  buffer_load_dwordx4 v[124:127], v1, s[8:11], s16 offen offset:1280 nt
  s_add_u32 s16, s16, s28
  s_waitcnt vmcnt(4)
  buffer_load_dwordx4 v[128:131], v1, s[8:11], s16 offen offset:0 nt
  s_waitcnt vmcnt(4)
  buffer_load_dwordx4 v[132:135], v1, s[8:11], s16 offen offset:256 nt
  s_waitcnt vmcnt(4)
  buffer_load_dwordx4 v[136:139], v1, s[8:11], s16 offen offset:1024 nt
  s_waitcnt vmcnt(4)
  buffer_load_dwordx4 v[140:143], v1, s[8:11], s16 offen offset:1280 nt
  s_add_u32 s16, s16, s28
  s_waitcnt vmcnt(4)
  buffer_load_dwordx4 v[144:147], v1, s[8:11], s16 offen offset:0 nt
  s_barrier
  s_waitcnt vmcnt(4)
  buffer_load_dwordx4 v[148:151], v1, s[8:11], s16 offen offset:256 nt
  s_waitcnt vmcnt(4)
  buffer_load_dwordx4 v[152:155], v1, s[8:11], s16 offen offset:1024 nt
  s_waitcnt vmcnt(4)
  buffer_load_dwordx4 v[156:159], v1, s[8:11], s16 offen offset:1280 nt
  s_add_u32 s16, s16, s28
  s_waitcnt vmcnt(4)
  buffer_load_dwordx4 v[160:163], v1, s[8:11], s16 offen offset:0 nt
  s_waitcnt vmcnt(4)
  buffer_load_dwordx4 v[164:167], v1, s[8:11], s16 offen offset:256 nt
  s_waitcnt vmcnt(4)
  buffer_load_dwordx4 v[168:171], v1, s[8:11], s16 offen offset:1024 nt
  s_waitcnt vmcnt(4)
  buffer_load_dwordx4 v[172:175], v1, s[8:11], s16 offen offset:1280 nt
  s_add_u32 s16, s16, s28
  s_waitcnt vmcnt(4)
  buffer_load_dwordx4 v[176:179], v1, s[8:11], s16 offen offset:0 nt
  s_waitcnt vmcnt(4)
  buffer_load_dwordx4 v[180:183], v1, s[8:11], s16 offen offset:256 nt
  s_waitcnt vmcnt(4)
  buffer_load_dwordx4 v[184:187], v1, s[8:11], s16 offen offset:1024 nt
  s_waitcnt vmcnt(4)
  buffer_load_dwordx4 v[188:191], v1, s[8:11], s16 offen offset:1280 nt
  s_add_u32 s16, s16, s28
  s_waitcnt lgkmcnt(0)
  s_barrier
  ds_read_b128 v[8:11], v52 offset:0
  ds_read_b128 v[12:15], v52 offset:256
  s_waitcnt lgkmcnt(0)
L_kC:
  v_mfma_f32_16x16x32_bf16 v[16:19], v[192:195], v[8:11], 0
  v_add_f32_dpp v34, v25, v24 quad_perm:[1,1,1,1] row_mask:0xf bank_mask:0xf
  v_cvt_pk_bf16_f32 v38, v32, v33
  v_max3_f32 v4, v4, v32, v33
  s_waitcnt vmcnt(5)
  s_cbranch_vccnz L_w1
  s_waitcnt vmcnt(4)
L_w1:
  buffer_load_dwordx4 v[192:195], v1, s[8:11], s16 offen offset:0 nt
  v_add_u32 v61, 2, v61
  ds_write_b32 v63, v61 offset:18512
  ds_read_b32 v62, v60 offset:18496
  ds_read_b128 v[56:59], v60 offset:18512
  v_mfma_f32_16x16x32_bf16 v[16:19], v[196:199], v[12:15], v[16:19]
  v_add_f32_dpp v34, v26, v34 quad_perm:[2,2,2,2] row_mask:0xf bank_mask:0xf
  s_waitcnt vmcnt(5)
  s_cbranch_vccnz L_w2
  s_waitcnt vmcnt(4)
L_w2:
  buffer_load_dwordx4 v[196:199], v1, s[8:11], s16 offen offset:256 nt
  s_waitcnt lgkmcnt(0)
  v_max3_u32 v55, v56, v57, v58
  v_min3_u32 v54, v56, v57, v58
  v_max_u32 v55, v55, v59
  v_min_u32 v54, v54, v59
  v_sub_u32 v55, v55, v61
  v_sub_u32 v54, v61, v54
  v_cmp_le_u32 vcc, 2, v55
  v_cmp_eq_u32 s[30:31], 1, v62
  v_cmp_gt_u32 s[32:33], 4, v54
  s_and_b64 s[30:31], s[30:31], s[32:33]
  s_or_b64 vcc, vcc, s[30:31]
  v_add_f32_dpp v34, v27, v34 quad_perm:[3,3,3,3] row_mask:0xf bank_mask:0xf
  v_mfma_f32_16x16x32_bf16 v[20:23], v[200:203], v[8:11], 0
  v_add_f32_dpp v35, v29, v28 quad_perm:[1,1,1,1] row_mask:0xf bank_mask:0xf
  s_waitcnt vmcnt(5)
  s_cbranch_vccnz L_w3
  s_waitcnt vmcnt(4)
L_w3:
  buffer_load_dwordx4 v[200:203], v1, s[8:11], s16 offen offset:1024 nt
  v_add_u32 v61, 2, v61
  ds_write_b32 v63, v61 offset:18512
  ds_read_b32 v62, v60 offset:18496
  ds_read_b128 v[56:59], v60 offset:18512
  v_mfma_f32_16x16x32_bf16 v[20:23], v[204:207], v[12:15], v[20:23]
  v_add_f32_dpp v35, v30, v35 quad_perm:[2,2,2,2] row_mask:0xf bank_mask:0xf
  s_waitcnt vmcnt(5)
  s_cbranch_vccnz L_w4
  s_waitcnt vmcnt(4)
L_w4:
  buffer_load_dwordx4 v[204:207], v1, s[8:11], s16 offen offset:1280 nt
  s_add_u32 s16, s16, s28
  s_waitcnt lgkmcnt(0)
  v_max3_u32 v55, v56, v57, v58
  v_min3_u32 v54, v56, v57, v58
  v_max_u32 v55, v55, v59
  v_min_u32 v54, v54, v59
  v_sub_u32 v55, v55, v61
  v_sub_u32 v54, v61, v54
  v_cmp_le_u32 vcc, 2, v55
  v_cmp_eq_u32 s[30:31], 1, v62
  v_cmp_gt_u32 s[32:33], 4, v54
  s_and_b64 s[30:31], s[30:31], s[32:33]
  s_or_b64 vcc, vcc, s[30:31]
  v_add_f32_dpp v35, v31, v35 quad_perm:[3,3,3,3] row_mask:0xf bank_mask:0xf
  v_mfma_f32_16x16x32_bf16 v[24:27], v[208:211], v[8:11], 0
  v_add_f32_dpp v32, v17, v16 quad_perm:[1,1,1,1] row_mask:0xf bank_mask:0xf
  v_cvt_pk_bf16_f32 v39, v34, v35
  v_max3_f32 v4, v4, v34, v35
  s_mov_b64 exec, s[24:25]
  ds_write_b128 v3, v[36:39]
  s_mov_b64 exec, -1
  v_add_u32 v3, 128, v3
  s_waitcnt vmcnt(5)
  s_cbranch_vccnz L_w5
  s_waitcnt vmcnt(4)
L_w5:
  buffer_load_dwordx4 v[208:211], v1, s[8:11], s16 offen offset:0 nt
  v_add_u32 v61, 2, v61
  ds_write_b32 v63, v61 offset:18512
  ds_read_b32 v62, v60 offset:18496
  ds_read_b128 v[56:59], v60 offset:18512
  v_mfma_f32_16x16x32_bf16 v[24:27], v[212:215], v[12:15], v[24:27]
  v_add_f32_dpp v32, v18, v32 quad_perm:[2,2,2,2] row_mask:0xf bank_mask:0xf
  s_waitcnt vmcnt(5)
  s_cbranch_vccnz L_w6
  s_waitcnt vmcnt(4)
L_w6:
  buffer_load_dwordx4 v[212:215], v1, s[8:11], s16 offen offset:256 nt
  s_waitcnt lgkmcnt(0)
  v_max3_u32 v55, v56, v57, v58
  v_min3_u32 v54, v56, v57, v58
  v_max_u32 v55, v55, v59
  v_min_u32 v54, v54, v59
  v_sub_u32 v55, v55, v61
  v_sub_u32 v54, v61, v54
  v_cmp_le_u32 vcc, 2, v55
  v_cmp_eq_u32 s[30:31], 1, v62
  v_cmp_gt_u32 s[32:33], 4, v54
  s_and_b64 s[30:31], s[30:31], s[32:33]
  s_or_b64 vcc, vcc, s[30:31]
  v_add_f32_dpp v32, v19, v32 quad_perm:[3,3,3,3] row_mask:0xf bank_mask:0xf
  v_mfma_f32_16x16x32_bf16 v[28:31], v[216:219], v[8:11], 0
  v_add_f32_dpp v33, v21, v20 quad_perm:[1,1,1,1] row_mask:0xf bank_mask:0xf
  s_waitcnt vmcnt(5)
  s_cbranch_vccnz L_w7
  s_waitcnt vmcnt(4)
L_w7:
  buffer_load_dwordx4 v[216:219], v1, s[8:11], s16 offen offset:1024 nt
  v_add_u32 v61, 2, v61
  ds_write_b32 v63, v61 offset:18512
  ds_read_b32 v62, v60 offset:18496
  ds_read_b128 v[56:59], v60 offset:18512
  v_mfma_f32_16x16x32_bf16 v[28:31], v[220:223], v[12:15], v[28:31]
  v_add_f32_dpp v33, v22, v33 quad_perm:[2,2,2,2] row_mask:0xf bank_mask:0xf
  s_waitcnt vmcnt(5)
  s_cbranch_vccnz L_w8
  s_waitcnt vmcnt(4)
L_w8:
  buffer_load_dwordx4 v[220:223], v1, s[8:11], s16 offen offset:1280 nt
  s_add_u32 s16, s16, s28
  s_waitcnt lgkmcnt(0)
  v_max3_u32 v55, v56, v57, v58
  v_min3_u32 v54, v56, v57, v58
  v_max_u32 v55, v55, v59
  v_min_u32 v54, v54, v59
  v_sub_u32 v55, v55, v61
  v_sub_u32 v54, v61, v54
  v_cmp_le_u32 vcc, 2, v55
  v_cmp_eq_u32 s[30:31], 1, v62
  v_cmp_gt_u32 s[32:33], 4, v54
  s_and_b64 s[30:31], s[30:31], s[32:33]
  s_or_b64 vcc, vcc, s[30:31]
  v_add_f32_dpp v33, v23, v33 quad_perm:[3,3,3,3] row_mask:0xf bank_mask:0xf
  v_mfma_f32_16x16x32_bf16 v[16:19], v[224:227], v[8:11], 0
  v_add_f32_dpp v34, v25, v24 quad_perm:[1,1,1,1] row_mask:0xf bank_mask:0xf
  v_cvt_pk_bf16_f32 v36, v32, v33
  v_max3_f32 v4, v4, v32, v33
  s_waitcnt vmcnt(5)
  s_cbranch_vccnz L_w9
  s_waitcnt vmcnt(4)
L_w9:
  buffer_load_dwordx4 v[224:227], v1, s[8:11], s16 offen offset:0 nt
  v_add_u32 v61, 2, v61
  ds_write_b32 v63, v61 offset:18512
  ds_read_b32 v62, v60 offset:18496
  ds_read_b128 v[56:59], v60 offset:18512
  v_mfma_f32_16x16x32_bf16 v[16:19], v[228:231], v[12:15], v[16:19]
  v_add_f32_dpp v34, v26, v34 quad_perm:[2,2,2,2] row_mask:0xf bank_mask:0xf
  s_waitcnt vmcnt(5)
  s_cbranch_vccnz L_w10
  s_waitcnt vmcnt(4)
L_w10:
  buffer_load_dwordx4 v[228:231], v1, s[8:11], s16 offen offset:256 nt
  s_waitcnt lgkmcnt(0)
  v_max3_u32 v55, v56, v57, v58
  v_min3_u32 v54, v56, v57, v58
  v_max_u32 v55, v55, v59
  v_min_u32 v54, v54, v59
  v_sub_u32 v55, v55, v61
  v_sub_u32 v54, v61, v54
  v_cmp_le_u32 vcc, 2, v55
  v_cmp_eq_u32 s[30:31], 1, v62
  v_cmp_gt_u32 s[32:33], 4, v54
  s_and_b64 s[30:31], s[30:31], s[32:33]
  s_or_b64 vcc, vcc, s[30:31]
  v_add_f32_dpp v34, v27, v34 quad_perm:[3,3,3,3] row_mask:0xf bank_mask:0xf
  v_mfma_f32_16x16x32_bf16 v[20:23], v[232:235], v[8:11], 0
  v_add_f32_dpp v35, v29, v28 quad_perm:[1,1,1,1] row_mask:0xf bank_mask:0xf
  s_waitcnt vmcnt(5)
  s_cbranch_vccnz L_w11
  s_waitcnt vmcnt(4)
L_w11:
  buffer_load_dwordx4 v[232:235], v1, s[8:11], s16 offen offset:1024 nt
  v_add_u32 v61, 2, v61
  ds_write_b32 v63, v61 offset:18512
  ds_read_b32 v62, v60 offset:18496
  ds_read_b128 v[56:59], v60 offset:18512
  v_mfma_f32_16x16x32_bf16 v[20:23], v[236:239], v[12:15], v[20:23]
  v_add_f32_dpp v35, v30, v35 quad_perm:[2,2,2,2] row_mask:0xf bank_mask:0xf
  s_waitcnt vmcnt(5)
  s_cbranch_vccnz L_w12
  s_waitcnt vmcnt(4)
L_w12:
  buffer_load_dwordx4 v[236:239], v1, s[8:11], s16 offen offset:1280 nt
  s_add_u32 s16, s16, s28
  s_waitcnt lgkmcnt(0)
  v_max3_u32 v55, v56, v57, v58
  v_min3_u32 v54, v56, v57, v58
  v_max_u32 v55, v55, v59
  v_min_u32 v54, v54, v59
  v_sub_u32 v55, v55, v61
  v_sub_u32 v54, v61, v54
  v_cmp_le_u32 vcc, 2, v55
  v_cmp_eq_u32 s[30:31], 1, v62
  v_cmp_gt_u32 s[32:33], 4, v54
  s_and_b64 s[30:31], s[30:31], s[32:33]
  s_or_b64 vcc, vcc, s[30:31]
  v_add_f32_dpp v35, v31, v35 quad_perm:[3,3,3,3] row_mask:0xf bank_mask:0xf
  v_mfma_f32_16x16x32_bf16 v[24:27], v[240:243], v[8:11], 0
  v_add_f32_dpp v32, v17, v16 quad_perm:[1,1,1,1] row_mask:0xf bank_mask:0xf
  v_cvt_pk_bf16_f32 v37, v34, v35
  v_max3_f32 v4, v4, v34, v35
  s_waitcnt vmcnt(5)
  s_cbranch_vccnz L_w13
  s_waitcnt vmcnt(4)
L_w13:
  buffer_load_dwordx4 v[240:243], v1, s[8:11], s16 offen offset:0 nt
  v_add_u32 v61, 2, v61
  ds_write_b32 v63, v61 offset:18512
  ds_read_b32 v62, v60 offset:18496
  ds_read_b128 v[56:59], v60 offset:18512
  v_mfma_f32_16x16x32_bf16 v[24:27], v[244:247], v[12:15], v[24:27]
  v_add_f32_dpp v32, v18, v32 quad_perm:[2,2,2,2] row_mask:0xf bank_mask:0xf
  s_waitcnt vmcnt(5)
  s_cbranch_vccnz L_w14
  s_waitcnt vmcnt(4)
L_w14:
  buffer_load_dwordx4 v[244:247], v1, s[8:11], s16 offen offset:256 nt
  s_waitcnt lgkmcnt(0)
  v_max3_u32 v55, v56, v57, v58
  v_min3_u32 v54, v56, v57, v58
  v_max_u32 v55, v55, v59
  v_min_u32 v54, v54, v59
  v_sub_u32 v55, v55, v61
  v_sub_u32 v54, v61, v54
  v_cmp_le_u32 vcc, 2, v55
  v_cmp_eq_u32 s[30:31], 1, v62
  v_cmp_gt_u32 s[32:33], 4, v54
  s_and_b64 s[30:31], s[30:31], s[32:33]
  s_or_b64 vcc, vcc, s[30:31]
  v_add_f32_dpp v32, v19, v32 quad_perm:[3,3,3,3] row_mask:0xf bank_mask:0xf
  v_mfma_f32_16x16x32_bf16 v[28:31], v[248:251], v[8:11], 0
  v_add_f32_dpp v33, v21, v20 quad_perm:[1,1,1,1] row_mask:0xf bank_mask:0xf
  s_waitcnt vmcnt(5)
  s_cbranch_vccnz L_w15
  s_waitcnt vmcnt(4)
L_w15:
  buffer_load_dwordx4 v[248:251], v1, s[8:11], s16 offen offset:1024 nt
  v_add_u32 v61, 2, v61
  ds_write_b32 v63, v61 offset:18512
  ds_read_b32 v62, v60 offset:18496
  ds_read_b128 v[56:59], v60 offset:18512
  v_mfma_f32_16x16x32_bf16 v[28:31], v[252:255], v[12:15], v[28:31]
  v_add_f32_dpp v33, v22, v33 quad_perm:[2,2,2,2] row_mask:0xf bank_mask:0xf
  s_waitcnt vmcnt(5)
  s_cbranch_vccnz L_w16
  s_waitcnt vmcnt(4)
L_w16:
  buffer_load_dwordx4 v[252:255], v1, s[8:11], s16 offen offset:1280 nt
  s_add_u32 s16, s16, s28
  s_waitcnt lgkmcnt(0)
  v_max3_u32 v55, v56, v57, v58
  v_min3_u32 v54, v56, v57, v58
  v_max_u32 v55, v55, v59
  v_min_u32 v54, v54, v59
  v_sub_u32 v55, v55, v61
  v_sub_u32 v54, v61, v54
  v_cmp_le_u32 vcc, 2, v55
  v_cmp_eq_u32 s[30:31], 1, v62
  v_cmp_gt_u32 s[32:33], 4, v54
  s_and_b64 s[30:31], s[30:31], s[32:33]
  s_or_b64 vcc, vcc, s[30:31]
  v_add_f32_dpp v33, v23, v33 quad_perm:[3,3,3,3] row_mask:0xf bank_mask:0xf
  s_cmp_eq_u32 s17, 4
  s_cbranch_scc0 L_kA
  s_mov_b32 s8, s12
  s_mov_b32 s9, s13
  s_mov_b32 s16, 0
  v_mov_b32 v1, v2
L_kA:
  v_mfma_f32_16x16x32_bf16 v[16:19], v[64:67], v[8:11], 0
  v_add_f32_dpp v34, v25, v24 quad_perm:[1,1,1,1] row_mask:0xf bank_mask:0xf
  v_cvt_pk_bf16_f32 v38, v32, v33
  v_max3_f32 v4, v4, v32, v33
  s_waitcnt vmcnt(5)
  s_cbranch_vccnz L_w17
  s_waitcnt vmcnt(4)
L_w17:
  buffer_load_dwordx4 v[64:67], v1, s[8:11], s16 offen offset:0 nt
  v_add_u32 v61, 2, v61
  ds_write_b32 v63, v61 offset:18512
  ds_read_b32 v62, v60 offset:18496
  ds_read_b128 v[56:59], v60 offset:18512
  v_mfma_f32_16x16x32_bf16 v[16:19], v[68:71], v[12:15], v[16:19]
  v_add_f32_dpp v34, v26, v34 quad_perm:[2,2,2,2] row_mask:0xf bank_mask:0xf
  s_waitcnt vmcnt(5)
  s_cbranch_vccnz L_w18
  s_waitcnt vmcnt(4)
L_w18:
  buffer_load_dwordx4 v[68:71], v1, s[8:11], s16 offen offset:256 nt
  s_waitcnt lgkmcnt(0)
  v_max3_u32 v55, v56, v57, v58
  v_min3_u32 v54, v56, v57, v58
  v_max_u32 v55, v55, v59
  v_min_u32 v54, v54, v59
  v_sub_u32 v55, v55, v61
  v_sub_u32 v54, v61, v54
  v_cmp_le_u32 vcc, 2, v55
  v_cmp_eq_u32 s[30:31], 1, v62
  v_cmp_gt_u32 s[32:33], 4, v54
  s_and_b64 s[30:31], s[30:31], s[32:33]
  s_or_b64 vcc, vcc, s[30:31]
  v_add_f32_dpp v34, v27, v34 quad_perm:[3,3,3,3] row_mask:0xf bank_mask:0xf
  v_mfma_f32_16x16x32_bf16 v[20:23], v[72:75], v[8:11], 0
  v_add_f32_dpp v35, v29, v28 quad_perm:[1,1,1,1] row_mask:0xf bank_mask:0xf
  s_waitcnt vmcnt(5)
  s_cbranch_vccnz L_w19
  s_waitcnt vmcnt(4)
L_w19:
  buffer_load_dwordx4 v[72:75], v1, s[8:11], s16 offen offset:1024 nt
  v_add_u32 v61, 2, v61
  ds_write_b32 v63, v61 offset:18512
  ds_read_b32 v62, v60 offset:18496
  ds_read_b128 v[56:59], v60 offset:18512
  v_mfma_f32_16x16x32_bf16 v[20:23], v[76:79], v[12:15], v[20:23]
  v_add_f32_dpp v35, v30, v35 quad_perm:[2,2,2,2] row_mask:0xf bank_mask:0xf
  s_waitcnt vmcnt(5)
  s_cbranch_vccnz L_w20
  s_waitcnt vmcnt(4)
L_w20:
  buffer_load_dwordx4 v[76:79], v1, s[8:11], s16 offen offset:1280 nt
  s_add_u32 s16, s16, s28
  s_waitcnt lgkmcnt(0)
  v_max3_u32 v55, v56, v57, v58
  v_min3_u32 v54, v56, v57, v58
  v_max_u32 v55, v55, v59
  v_min_u32 v54, v54, v59
  v_sub_u32 v55, v55, v61
  v_sub_u32 v54, v61, v54
  v_cmp_le_u32 vcc, 2, v55
  v_cmp_eq_u32 s[30:31], 1, v62
  v_cmp_gt_u32 s[32:33], 4, v54
  s_and_b64 s[30:31], s[30:31], s[32:33]
  s_or_b64 vcc, vcc, s[30:31]
  v_add_f32_dpp v35, v31, v35 quad_perm:[3,3,3,3] row_mask:0xf bank_mask:0xf
  v_mfma_f32_16x16x32_bf16 v[24:27], v[80:83], v[8:11], 0
  v_add_f32_dpp v32, v17, v16 quad_perm:[1,1,1,1] row_mask:0xf bank_mask:0xf
  v_cvt_pk_bf16_f32 v39, v34, v35
  v_max3_f32 v4, v4, v34, v35
  s_mov_b64 exec, s[24:25]
  ds_write_b128 v3, v[36:39]
  s_mov_b64 exec, -1
  v_add_u32 v3, 128, v3
  s_waitcnt vmcnt(5)
  s_cbranch_vccnz L_w21
  s_waitcnt vmcnt(4)
L_w21:
  buffer_load_dwordx4 v[80:83], v1, s[8:11], s16 offen offset:0 nt
  v_add_u32 v61, 2, v61
  ds_write_b32 v63, v61 offset:18512
  ds_read_b32 v62, v60 offset:18496
  ds_read_b128 v[56:59], v60 offset:18512
  v_mfma_f32_16x16x32_bf16 v[24:27], v[84:87], v[12:15], v[24:27]
  v_add_f32_dpp v32, v18, v32 quad_perm:[2,2,2,2] row_mask:0xf bank_mask:0xf
  s_waitcnt vmcnt(5)
  s_cbranch_vccnz L_w22
  s_waitcnt vmcnt(4)
L_w22:
  buffer_load_dwordx4 v[84:87], v1, s[8:11], s16 offen offset:256 nt
  s_waitcnt lgkmcnt(0)
  v_max3_u32 v55, v56, v57, v58
  v_min3_u32 v54, v56, v57, v58
  v_max_u32 v55, v55, v59
  v_min_u32 v54, v54, v59
  v_sub_u32 v55, v55, v61
  v_sub_u32 v54, v61, v54
  v_cmp_le_u32 vcc, 2, v55
  v_cmp_eq_u32 s[30:31], 1, v62
  v_cmp_gt_u32 s[32:33], 4, v54
  s_and_b64 s[30:31], s[30:31], s[32:33]
  s_or_b64 vcc, vcc, s[30:31]
  v_add_f32_dpp v32, v19, v32 quad_perm:[3,3,3,3] row_mask:0xf bank_mask:0xf
  v_mfma_f32_16x16x32_bf16 v[28:31], v[88:91], v[8:11], 0
  v_add_f32_dpp v33, v21, v20 quad_perm:[1,1,1,1] row_mask:0xf bank_mask:0xf
  s_waitcnt vmcnt(5)
  s_cbranch_vccnz L_w23
  s_waitcnt vmcnt(4)
L_w23:
  buffer_load_dwordx4 v[88:91], v1, s[8:11], s16 offen offset:1024 nt
  v_add_u32 v61, 2, v61
  ds_write_b32 v63, v61 offset:18512
  ds_read_b32 v62, v60 offset:18496
  ds_read_b128 v[56:59], v60 offset:18512
  v_mfma_f32_16x16x32_bf16 v[28:31], v[92:95], v[12:15], v[28:31]
  v_add_f32_dpp v33, v22, v33 quad_perm:[2,2,2,2] row_mask:0xf bank_mask:0xf
  s_waitcnt vmcnt(5)
  s_cbranch_vccnz L_w24
  s_waitcnt vmcnt(4)
L_w24:
  buffer_load_dwordx4 v[92:95], v1, s[8:11], s16 offen offset:1280 nt
  s_add_u32 s16, s16, s28
  s_waitcnt lgkmcnt(0)
  v_max3_u32 v55, v56, v57, v58
  v_min3_u32 v54, v56, v57, v58
  v_max_u32 v55, v55, v59
  v_min_u32 v54, v54, v59
  v_sub_u32 v55, v55, v61
  v_sub_u32 v54, v61, v54
  v_cmp_le_u32 vcc, 2, v55
  v_cmp_eq_u32 s[30:31], 1, v62
  v_cmp_gt_u32 s[32:33], 4, v54
  s_and_b64 s[30:31], s[30:31], s[32:33]
  s_or_b64 vcc, vcc, s[30:31]
  v_add_f32_dpp v33, v23, v33 quad_perm:[3,3,3,3] row_mask:0xf bank_mask:0xf
  v_mfma_f32_16x16x32_bf16 v[16:19], v[96:99], v[8:11], 0
  v_add_f32_dpp v34, v25, v24 quad_perm:[1,1,1,1] row_mask:0xf bank_mask:0xf
  v_cvt_pk_bf16_f32 v36, v32, v33
  v_max3_f32 v4, v4, v32, v33
  s_waitcnt vmcnt(5)
  s_cbranch_vccnz L_w25
  s_waitcnt vmcnt(4)
L_w25:
  buffer_load_dwordx4 v[96:99], v1, s[8:11], s16 offen offset:0 nt
  v_add_u32 v61, 2, v61
  ds_write_b32 v63, v61 offset:18512
  ds_read_b32 v62, v60 offset:18496
  ds_read_b128 v[56:59], v60 offset:18512
  v_mfma_f32_16x16x32_bf16 v[16:19], v[100:103], v[12:15], v[16:19]
  v_add_f32_dpp v34, v26, v34 quad_perm:[2,2,2,2] row_mask:0xf bank_mask:0xf
  s_waitcnt vmcnt(5)
  s_cbranch_vccnz L_w26
  s_waitcnt vmcnt(4)
L_w26:
  buffer_load_dwordx4 v[100:103], v1, s[8:11], s16 offen offset:256 nt
  s_waitcnt lgkmcnt(0)
  v_max3_u32 v55, v56, v57, v58
  v_min3_u32 v54, v56, v57, v58
  v_max_u32 v55, v55, v59
  v_min_u32 v54, v54, v59
  v_sub_u32 v55, v55, v61
  v_sub_u32 v54, v61, v54
  v_cmp_le_u32 vcc, 2, v55
  v_cmp_eq_u32 s[30:31], 1, v62
  v_cmp_gt_u32 s[32:33], 4, v54
  s_and_b64 s[30:31], s[30:31], s[32:33]
  s_or_b64 vcc, vcc, s[30:31]
  v_add_f32_dpp v34, v27, v34 quad_perm:[3,3,3,3] row_mask:0xf bank_mask:0xf
  v_mfma_f32_16x16x32_bf16 v[20:23], v[104:107], v[8:11], 0
  v_add_f32_dpp v35, v29, v28 quad_perm:[1,1,1,1] row_mask:0xf bank_mask:0xf
  s_waitcnt vmcnt(5)
  s_cbranch_vccnz L_w27
  s_waitcnt vmcnt(4)
L_w27:
  buffer_load_dwordx4 v[104:107], v1, s[8:11], s16 offen offset:1024 nt
  v_add_u32 v61, 2, v61
  ds_write_b32 v63, v61 offset:18512
  ds_read_b32 v62, v60 offset:18496
  ds_read_b128 v[56:59], v60 offset:18512
  v_mfma_f32_16x16x32_bf16 v[20:23], v[108:111], v[12:15], v[20:23]
  v_add_f32_dpp v35, v30, v35 quad_perm:[2,2,2,2] row_mask:0xf bank_mask:0xf
  s_waitcnt vmcnt(5)
  s_cbranch_vccnz L_w28
  s_waitcnt vmcnt(4)
L_w28:
  buffer_load_dwordx4 v[108:111], v1, s[8:11], s16 offen offset:1280 nt
  s_add_u32 s16, s16, s28
  s_waitcnt lgkmcnt(0)
  v_max3_u32 v55, v56, v57, v58
  v_min3_u32 v54, v56, v57, v58
  v_max_u32 v55, v55, v59
  v_min_u32 v54, v54, v59
  v_sub_u32 v55, v55, v61
  v_sub_u32 v54, v61, v54
  v_cmp_le_u32 vcc, 2, v55
  v_cmp_eq_u32 s[30:31], 1, v62
  v_cmp_gt_u32 s[32:33], 4, v54
  s_and_b64 s[30:31], s[30:31], s[32:33]
  s_or_b64 vcc, vcc, s[30:31]
  v_add_f32_dpp v35, v31, v35 quad_perm:[3,3,3,3] row_mask:0xf bank_mask:0xf
  v_mfma_f32_16x16x32_bf16 v[24:27], v[112:115], v[8:11], 0
  v_add_f32_dpp v32, v17, v16 quad_perm:[1,1,1,1] row_mask:0xf bank_mask:0xf
  v_cvt_pk_bf16_f32 v37, v34, v35
  v_max3_f32 v4, v4, v34, v35
  s_waitcnt vmcnt(5)
  s_cbranch_vccnz L_w29
  s_waitcnt vmcnt(4)
L_w29:
  buffer_load_dwordx4 v[112:115], v1, s[8:11], s16 offen offset:0 nt
  v_add_u32 v61, 2, v61
  ds_write_b32 v63, v61 offset:18512
  ds_read_b32 v62, v60 offset:18496
  ds_read_b128 v[56:59], v60 offset:18512
  v_mfma_f32_16x16x32_bf16 v[24:27], v[116:119], v[12:15], v[24:27]
  v_add_f32_dpp v32, v18, v32 quad_perm:[2,2,2,2] row_mask:0xf bank_mask:0xf
  s_waitcnt vmcnt(5)
  s_cbranch_vccnz L_w30
  s_waitcnt vmcnt(4)
L_w30:
  buffer_load_dwordx4 v[116:119], v1, s[8:11], s16 offen offset:256 nt
  s_waitcnt lgkmcnt(0)
  v_max3_u32 v55, v56, v57, v58
  v_min3_u32 v54, v56, v57, v58
  v_max_u32 v55, v55, v59
  v_min_u32 v54, v54, v59
  v_sub_u32 v55, v55, v61
  v_sub_u32 v54, v61, v54
  v_cmp_le_u32 vcc, 2, v55
  v_cmp_eq_u32 s[30:31], 1, v62
  v_cmp_gt_u32 s[32:33], 4, v54
  s_and_b64 s[30:31], s[30:31], s[32:33]
  s_or_b64 vcc, vcc, s[30:31]
  v_add_f32_dpp v32, v19, v32 quad_perm:[3,3,3,3] row_mask:0xf bank_mask:0xf
  v_mfma_f32_16x16x32_bf16 v[28:31], v[120:123], v[8:11], 0
  v_add_f32_dpp v33, v21, v20 quad_perm:[1,1,1,1] row_mask:0xf bank_mask:0xf
  s_waitcnt vmcnt(5)
  s_cbranch_vccnz L_w31
  s_waitcnt vmcnt(4)
L_w31:
  buffer_load_dwordx4 v[120:123], v1, s[8:11], s16 offen offset:1024 nt
  v_add_u32 v61, 2, v61
  ds_write_b32 v63, v61 offset:18512
  ds_read_b32 v62, v60 offset:18496
  ds_read_b128 v[56:59], v60 offset:18512
  v_mfma_f32_16x16x32_bf16 v[28:31], v[124:127], v[12:15], v[28:31]
  v_add_f32_dpp v33, v22, v33 quad_perm:[2,2,2,2] row_mask:0xf bank_mask:0xf
  s_waitcnt vmcnt(5)
  s_cbranch_vccnz L_w32
  s_waitcnt vmcnt(4)
L_w32:
  buffer_load_dwordx4 v[124:127], v1, s[8:11], s16 offen offset:1280 nt
  s_add_u32 s16, s16, s28
  s_waitcnt lgkmcnt(0)
  v_max3_u32 v55, v56, v57, v58
  v_min3_u32 v54, v56, v57, v58
  v_max_u32 v55, v55, v59
  v_min_u32 v54, v54, v59
  v_sub_u32 v55, v55, v61
  v_sub_u32 v54, v61, v54
  v_cmp_le_u32 vcc, 2, v55
  v_cmp_eq_u32 s[30:31], 1, v62
  v_cmp_gt_u32 s[32:33], 4, v54
  s_and_b64 s[30:31], s[30:31], s[32:33]
  s_or_b64 vcc, vcc, s[30:31]
  v_add_f32_dpp v33, v23, v33 quad_perm:[3,3,3,3] row_mask:0xf bank_mask:0xf
  s_cmp_eq_u32 s17, 4
  s_cbranch_scc1 L_T
  v_mfma_f32_16x16x32_bf16 v[16:19], v[128:131], v[8:11], 0
  v_add_f32_dpp v34, v25, v24 quad_perm:[1,1,1,1] row_mask:0xf bank_mask:0xf
  v_cvt_pk_bf16_f32 v38, v32, v33
  v_max3_f32 v4, v4, v32, v33
  s_waitcnt vmcnt(5)
  s_cbranch_vccnz L_w33
  s_waitcnt vmcnt(4)
L_w33:
  buffer_load_dwordx4 v[128:131], v1, s[8:11], s16 offen offset:0 nt
  v_add_u32 v61, 2, v61
  ds_write_b32 v63, v61 offset:18512
  ds_read_b32 v62, v60 offset:18496
  ds_read_b128 v[56:59], v60 offset:18512
  v_mfma_f32_16x16x32_bf16 v[16:19], v[132:135], v[12:15], v[16:19]
  v_add_f32_dpp v34, v26, v34 quad_perm:[2,2,2,2] row_mask:0xf bank_mask:0xf
  s_waitcnt vmcnt(5)
  s_cbranch_vccnz L_w34
  s_waitcnt vmcnt(4)
L_w34:
  buffer_load_dwordx4 v[132:135], v1, s[8:11], s16 offen offset:256 nt
  s_waitcnt lgkmcnt(0)
  v_max3_u32 v55, v56, v57, v58
  v_min3_u32 v54, v56, v57, v58
  v_max_u32 v55, v55, v59
  v_min_u32 v54, v54, v59
  v_sub_u32 v55, v55, v61
  v_sub_u32 v54, v61, v54
  v_cmp_le_u32 vcc, 2, v55
  v_cmp_eq_u32 s[30:31], 1, v62
  v_cmp_gt_u32 s[32:33], 4, v54
  s_and_b64 s[30:31], s[30:31], s[32:33]
  s_or_b64 vcc, vcc, s[30:31]
  v_add_f32_dpp v34, v27, v34 quad_perm:[3,3,3,3] row_mask:0xf bank_mask:0xf
  v_mfma_f32_16x16x32_bf16 v[20:23], v[136:139], v[8:11], 0
  v_add_f32_dpp v35, v29, v28 quad_perm:[1,1,1,1] row_mask:0xf bank_mask:0xf
  s_waitcnt vmcnt(5)
  s_cbranch_vccnz L_w35
  s_waitcnt vmcnt(4)
L_w35:
  buffer_load_dwordx4 v[136:139], v1, s[8:11], s16 offen offset:1024 nt
  v_add_u32 v61, 2, v61
  ds_write_b32 v63, v61 offset:18512
  ds_read_b32 v62, v60 offset:18496
  ds_read_b128 v[56:59], v60 offset:18512
  v_mfma_f32_16x16x32_bf16 v[20:23], v[140:143], v[12:15], v[20:23]
  v_add_f32_dpp v35, v30, v35 quad_perm:[2,2,2,2] row_mask:0xf bank_mask:0xf
  s_waitcnt vmcnt(5)
  s_cbranch_vccnz L_w36
  s_waitcnt vmcnt(4)
L_w36:
  buffer_load_dwordx4 v[140:143], v1, s[8:11], s16 offen offset:1280 nt
  s_add_u32 s16, s16, s28
  s_waitcnt lgkmcnt(0)
  v_max3_u32 v55, v56, v57, v58
  v_min3_u32 v54, v56, v57, v58
  v_max_u32 v55, v55, v59
  v_min_u32 v54, v54, v59
  v_sub_u32 v55, v55, v61
  v_sub_u32 v54, v61, v54
  v_cmp_le_u32 vcc, 2, v55
  v_cmp_eq_u32 s[30:31], 1, v62
  v_cmp_gt_u32 s[32:33], 4, v54
  s_and_b64 s[30:31], s[30:31], s[32:33]
  s_or_b64 vcc, vcc, s[30:31]
  v_add_f32_dpp v35, v31, v35 quad_perm:[3,3,3,3] row_mask:0xf bank_mask:0xf
  v_mfma_f32_16x16x32_bf16 v[24:27], v[144:147], v[8:11], 0
  v_add_f32_dpp v32, v17, v16 quad_perm:[1,1,1,1] row_mask:0xf bank_mask:0xf
  v_cvt_pk_bf16_f32 v39, v34, v35
  v_max3_f32 v4, v4, v34, v35
  s_mov_b64 exec, s[24:25]
  ds_write_b128 v3, v[36:39]
  s_mov_b64 exec, -1
  v_add_u32 v3, 128, v3
  s_waitcnt vmcnt(5)
  s_cbranch_vccnz L_w37
  s_waitcnt vmcnt(4)
L_w37:
  buffer_load_dwordx4 v[144:147], v1, s[8:11], s16 offen offset:0 nt
  v_add_u32 v61, 2, v61
  ds_write_b32 v63, v61 offset:18512
  ds_read_b32 v62, v60 offset:18496
  ds_read_b128 v[56:59], v60 offset:18512
  v_mfma_f32_16x16x32_bf16 v[24:27], v[148:151], v[12:15], v[24:27]
  v_add_f32_dpp v32, v18, v32 quad_perm:[2,2,2,2] row_mask:0xf bank_mask:0xf
  s_waitcnt vmcnt(5)
  s_cbranch_vccnz L_w38
  s_waitcnt vmcnt(4)
L_w38:
  buffer_load_dwordx4 v[148:151], v1, s[8:11], s16 offen offset:256 nt
  s_waitcnt lgkmcnt(0)
  v_max3_u32 v55, v56, v57, v58
  v_min3_u32 v54, v56, v57, v58
  v_max_u32 v55, v55, v59
  v_min_u32 v54, v54, v59
  v_sub_u32 v55, v55, v61
  v_sub_u32 v54, v61, v54
  v_cmp_le_u32 vcc, 2, v55
  v_cmp_eq_u32 s[30:31], 1, v62
  v_cmp_gt_u32 s[32:33], 4, v54
  s_and_b64 s[30:31], s[30:31], s[32:33]
  s_or_b64 vcc, vcc, s[30:31]
  v_add_f32_dpp v32, v19, v32 quad_perm:[3,3,3,3] row_mask:0xf bank_mask:0xf
  v_mfma_f32_16x16x32_bf16 v[28:31], v[152:155], v[8:11], 0
  v_add_f32_dpp v33, v21, v20 quad_perm:[1,1,1,1] row_mask:0xf bank_mask:0xf
  s_waitcnt vmcnt(5)
  s_cbranch_vccnz L_w39
  s_waitcnt vmcnt(4)
L_w39:
  buffer_load_dwordx4 v[152:155], v1, s[8:11], s16 offen offset:1024 nt
  v_add_u32 v61, 2, v61
  ds_write_b32 v63, v61 offset:18512
  ds_read_b32 v62, v60 offset:18496
  ds_read_b128 v[56:59], v60 offset:18512
  v_mfma_f32_16x16x32_bf16 v[28:31], v[156:159], v[12:15], v[28:31]
  v_add_f32_dpp v33, v22, v33 quad_perm:[2,2,2,2] row_mask:0xf bank_mask:0xf
  s_waitcnt vmcnt(5)
  s_cbranch_vccnz L_w40
  s_waitcnt vmcnt(4)
L_w40:
  buffer_load_dwordx4 v[156:159], v1, s[8:11], s16 offen offset:1280 nt
  s_add_u32 s16, s16, s28
  s_waitcnt lgkmcnt(0)
  v_max3_u32 v55, v56, v57, v58
  v_min3_u32 v54, v56, v57, v58
  v_max_u32 v55, v55, v59
  v_min_u32 v54, v54, v59
  v_sub_u32 v55, v55, v61
  v_sub_u32 v54, v61, v54
  v_cmp_le_u32 vcc, 2, v55
  v_cmp_eq_u32 s[30:31], 1, v62
  v_cmp_gt_u32 s[32:33], 4, v54
  s_and_b64 s[30:31], s[30:31], s[32:33]
  s_or_b64 vcc, vcc, s[30:31]
  v_add_f32_dpp v33, v23, v33 quad_perm:[3,3,3,3] row_mask:0xf bank_mask:0xf
  v_mfma_f32_16x16x32_bf16 v[16:19], v[160:163], v[8:11], 0
  v_add_f32_dpp v34, v25, v24 quad_perm:[1,1,1,1] row_mask:0xf bank_mask:0xf
  v_cvt_pk_bf16_f32 v36, v32, v33
  v_max3_f32 v4, v4, v32, v33
  s_waitcnt vmcnt(5)
  s_cbranch_vccnz L_w41
  s_waitcnt vmcnt(4)
L_w41:
  buffer_load_dwordx4 v[160:163], v1, s[8:11], s16 offen offset:0 nt
  v_add_u32 v61, 2, v61
  ds_write_b32 v63, v61 offset:18512
  ds_read_b32 v62, v60 offset:18496
  ds_read_b128 v[56:59], v60 offset:18512
  v_mfma_f32_16x16x32_bf16 v[16:19], v[164:167], v[12:15], v[16:19]
  v_add_f32_dpp v34, v26, v34 quad_perm:[2,2,2,2] row_mask:0xf bank_mask:0xf
  s_waitcnt vmcnt(5)
  s_cbranch_vccnz L_w42
  s_waitcnt vmcnt(4)
L_w42:
  buffer_load_dwordx4 v[164:167], v1, s[8:11], s16 offen offset:256 nt
  s_waitcnt lgkmcnt(0)
  v_max3_u32 v55, v56, v57, v58
  v_min3_u32 v54, v56, v57, v58
  v_max_u32 v55, v55, v59
  v_min_u32 v54, v54, v59
  v_sub_u32 v55, v55, v61
  v_sub_u32 v54, v61, v54
  v_cmp_le_u32 vcc, 2, v55
  v_cmp_eq_u32 s[30:31], 1, v62
  v_cmp_gt_u32 s[32:33], 4, v54
  s_and_b64 s[30:31], s[30:31], s[32:33]
  s_or_b64 vcc, vcc, s[30:31]
  v_add_f32_dpp v34, v27, v34 quad_perm:[3,3,3,3] row_mask:0xf bank_mask:0xf
  v_mfma_f32_16x16x32_bf16 v[20:23], v[168:171], v[8:11], 0
  v_add_f32_dpp v35, v29, v28 quad_perm:[1,1,1,1] row_mask:0xf bank_mask:0xf
  s_waitcnt vmcnt(5)
  s_cbranch_vccnz L_w43
  s_waitcnt vmcnt(4)
L_w43:
  buffer_load_dwordx4 v[168:171], v1, s[8:11], s16 offen offset:1024 nt
  v_add_u32 v61, 2, v61
  ds_write_b32 v63, v61 offset:18512
  ds_read_b32 v62, v60 offset:18496
  ds_read_b128 v[56:59], v60 offset:18512
  v_mfma_f32_16x16x32_bf16 v[20:23], v[172:175], v[12:15], v[20:23]
  v_add_f32_dpp v35, v30, v35 quad_perm:[2,2,2,2] row_mask:0xf bank_mask:0xf
  s_waitcnt vmcnt(5)
  s_cbranch_vccnz L_w44
  s_waitcnt vmcnt(4)
L_w44:
  buffer_load_dwordx4 v[172:175], v1, s[8:11], s16 offen offset:1280 nt
  s_add_u32 s16, s16, s28
  s_waitcnt lgkmcnt(0)
  v_max3_u32 v55, v56, v57, v58
  v_min3_u32 v54, v56, v57, v58
  v_max_u32 v55, v55, v59
  v_min_u32 v54, v54, v59
  v_sub_u32 v55, v55, v61
  v_sub_u32 v54, v61, v54
  v_cmp_le_u32 vcc, 2, v55
  v_cmp_eq_u32 s[30:31], 1, v62
  v_cmp_gt_u32 s[32:33], 4, v54
  s_and_b64 s[30:31], s[30:31], s[32:33]
  s_or_b64 vcc, vcc, s[30:31]
  v_add_f32_dpp v35, v31, v35 quad_perm:[3,3,3,3] row_mask:0xf bank_mask:0xf
  v_mfma_f32_16x16x32_bf16 v[24:27], v[176:179], v[8:11], 0
  v_add_f32_dpp v32, v17, v16 quad_perm:[1,1,1,1] row_mask:0xf bank_mask:0xf
  v_cvt_pk_bf16_f32 v37, v34, v35
  v_max3_f32 v4, v4, v34, v35
  s_waitcnt vmcnt(5)
  s_cbranch_vccnz L_w45
  s_waitcnt vmcnt(4)
L_w45:
  buffer_load_dwordx4 v[176:179], v1, s[8:11], s16 offen offset:0 nt
  v_add_u32 v61, 2, v61
  ds_write_b32 v63, v61 offset:18512
  ds_read_b32 v62, v60 offset:18496
  ds_read_b128 v[56:59], v60 offset:18512
  v_mfma_f32_16x16x32_bf16 v[24:27], v[180:183], v[12:15], v[24:27]
  v_add_f32_dpp v32, v18, v32 quad_perm:[2,2,2,2] row_mask:0xf bank_mask:0xf
  s_waitcnt vmcnt(5)
  s_cbranch_vccnz L_w46
  s_waitcnt vmcnt(4)
L_w46:
  buffer_load_dwordx4 v[180:183], v1, s[8:11], s16 offen offset:256 nt
  s_waitcnt lgkmcnt(0)
  v_max3_u32 v55, v56, v57, v58
  v_min3_u32 v54, v56, v57, v58
  v_max_u32 v55, v55, v59
  v_min_u32 v54, v54, v59
  v_sub_u32 v55, v55, v61
  v_sub_u32 v54, v61, v54
  v_cmp_le_u32 vcc, 2, v55
  v_cmp_eq_u32 s[30:31], 1, v62
  v_cmp_gt_u32 s[32:33], 4, v54
  s_and_b64 s[30:31], s[30:31], s[32:33]
  s_or_b64 vcc, vcc, s[30:31]
  v_add_f32_dpp v32, v19, v32 quad_perm:[3,3,3,3] row_mask:0xf bank_mask:0xf
  v_mfma_f32_16x16x32_bf16 v[28:31], v[184:187], v[8:11], 0
  v_add_f32_dpp v33, v21, v20 quad_perm:[1,1,1,1] row_mask:0xf bank_mask:0xf
  s_waitcnt vmcnt(5)
  s_cbranch_vccnz L_w47
  s_waitcnt vmcnt(4)
L_w47:
  buffer_load_dwordx4 v[184:187], v1, s[8:11], s16 offen offset:1024 nt
  v_add_u32 v61, 2, v61
  ds_write_b32 v63, v61 offset:18512
  ds_read_b32 v62, v60 offset:18496
  ds_read_b128 v[56:59], v60 offset:18512
  v_mfma_f32_16x16x32_bf16 v[28:31], v[188:191], v[12:15], v[28:31]
  v_add_f32_dpp v33, v22, v33 quad_perm:[2,2,2,2] row_mask:0xf bank_mask:0xf
  s_waitcnt vmcnt(5)
  s_cbranch_vccnz L_w48
  s_waitcnt vmcnt(4)
L_w48:
  buffer_load_dwordx4 v[188:191], v1, s[8:11], s16 offen offset:1280 nt
  s_add_u32 s16, s16, s28
  s_waitcnt lgkmcnt(0)
  v_max3_u32 v55, v56, v57, v58
  v_min3_u32 v54, v56, v57, v58
  v_max_u32 v55, v55, v59
  v_min_u32 v54, v54, v59
  v_sub_u32 v55, v55, v61
  v_sub_u32 v54, v61, v54
  v_cmp_le_u32 vcc, 2, v55
  v_cmp_eq_u32 s[30:31], 1, v62
  v_cmp_gt_u32 s[32:33], 4, v54
  s_and_b64 s[30:31], s[30:31], s[32:33]
  s_or_b64 vcc, vcc, s[30:31]
  v_add_f32_dpp v33, v23, v33 quad_perm:[3,3,3,3] row_mask:0xf bank_mask:0xf
  s_add_u32 s17, s17, 1
  s_branch L_kC
L_T:
  v_mfma_f32_16x16x32_bf16 v[16:19], v[128:131], v[8:11], 0
  v_add_f32_dpp v34, v25, v24 quad_perm:[1,1,1,1] row_mask:0xf bank_mask:0xf
  v_cvt_pk_bf16_f32 v38, v32, v33
  v_max3_f32 v4, v4, v32, v33
  v_mfma_f32_16x16x32_bf16 v[16:19], v[132:135], v[12:15], v[16:19]
  v_add_f32_dpp v34, v26, v34 quad_perm:[2,2,2,2] row_mask:0xf bank_mask:0xf
  s_nop 1
  v_add_f32_dpp v34, v27, v34 quad_perm:[3,3,3,3] row_mask:0xf bank_mask:0xf
  s_waitcnt vmcnt(5)
  s_cbranch_vccnz L_w49
  s_waitcnt vmcnt(4)
L_w49:
  buffer_load_dwordx4 v[128:131], v1, s[8:11], s16 offen offset:0 nt
  v_mfma_f32_16x16x32_bf16 v[20:23], v[136:139], v[8:11], 0
  v_add_f32_dpp v35, v29, v28 quad_perm:[1,1,1,1] row_mask:0xf bank_mask:0xf
  v_mfma_f32_16x16x32_bf16 v[20:23], v[140:143], v[12:15], v[20:23]
  s_nop 0
  v_add_f32_dpp v35, v30, v35 quad_perm:[2,2,2,2] row_mask:0xf bank_mask:0xf
  s_nop 1
  v_add_f32_dpp v35, v31, v35 quad_perm:[3,3,3,3] row_mask:0xf bank_mask:0xf
  v_mfma_f32_16x16x32_bf16 v[24:27], v[144:147], v[8:11], 0
  v_add_f32_dpp v32, v17, v16 quad_perm:[1,1,1,1] row_mask:0xf bank_mask:0xf
  v_cvt_pk_bf16_f32 v39, v34, v35
  v_max3_f32 v4, v4, v34, v35
  s_mov_b64 exec, s[24:25]
  ds_write_b128 v3, v[36:39]
  s_mov_b64 exec, -1
  v_add_u32 v3, 128, v3
  v_mfma_f32_16x16x32_bf16 v[24:27], v[148:151], v[12:15], v[24:27]
  v_add_f32_dpp v32, v18, v32 quad_perm:[2,2,2,2] row_mask:0xf bank_mask:0xf
  s_nop 1
  v_add_f32_dpp v32, v19, v32 quad_perm:[3,3,3,3] row_mask:0xf bank_mask:0xf
  v_mfma_f32_16x16x32_bf16 v[28:31], v[152:155], v[8:11], 0
  v_add_f32_dpp v33, v21, v20 quad_perm:[1,1,1,1] row_mask:0xf bank_mask:0xf
  v_mfma_f32_16x16x32_bf16 v[28:31], v[156:159], v[12:15], v[28:31]
  s_nop 0
  v_add_f32_dpp v33, v22, v33 quad_perm:[2,2,2,2] row_mask:0xf bank_mask:0xf
  s_nop 1
  v_add_f32_dpp v33, v23, v33 quad_perm:[3,3,3,3] row_mask:0xf bank_mask:0xf
  v_add_u32 v61, 2, v61
  ds_write_b32 v63, v61 offset:18512
  ds_read_b32 v62, v60 offset:18496
  ds_read_b128 v[56:59], v60 offset:18512
  s_waitcnt vmcnt(5)
  s_cbranch_vccnz L_w50
  s_waitcnt vmcnt(4)
L_w50:
  buffer_load_dwordx4 v[132:135], v1, s[8:11], s16 offen offset:256 nt
  v_mfma_f32_16x16x32_bf16 v[16:19], v[160:163], v[8:11], 0
  v_add_f32_dpp v34, v25, v24 quad_perm:[1,1,1,1] row_mask:0xf bank_mask:0xf
  v_cvt_pk_bf16_f32 v36, v32, v33
  v_max3_f32 v4, v4, v32, v33
  v_mfma_f32_16x16x32_bf16 v[16:19], v[164:167], v[12:15], v[16:19]
  v_add_f32_dpp v34, v26, v34 quad_perm:[2,2,2,2] row_mask:0xf bank_mask:0xf
  s_nop 1
  v_add_f32_dpp v34, v27, v34 quad_perm:[3,3,3,3] row_mask:0xf bank_mask:0xf
  v_mfma_f32_16x16x32_bf16 v[20:23], v[168:171], v[8:11], 0
  v_add_f32_dpp v35, v29, v28 quad_perm:[1,1,1,1] row_mask:0xf bank_mask:0xf
  v_mfma_f32_16x16x32_bf16 v[20:23], v[172:175], v[12:15], v[20:23]
  s_nop 0
  v_add_f32_dpp v35, v30, v35 quad_perm:[2,2,2,2] row_mask:0xf bank_mask:0xf
  s_nop 1
  v_add_f32_dpp v35, v31, v35 quad_perm:[3,3,3,3] row_mask:0xf bank_mask:0xf
  v_mfma_f32_16x16x32_bf16 v[24:27], v[176:179], v[8:11], 0
  v_add_f32_dpp v32, v17, v16 quad_perm:[1,1,1,1] row_mask:0xf bank_mask:0xf
  v_cvt_pk_bf16_f32 v37, v34, v35
  v_max3_f32 v4, v4, v34, v35
  v_mfma_f32_16x16x32_bf16 v[24:27], v[180:183], v[12:15], v[24:27]
  v_add_f32_dpp v32, v18, v32 quad_perm:[2,2,2,2] row_mask:0xf bank_mask:0xf
  s_nop 1
  v_add_f32_dpp v32, v19, v32 quad_perm:[3,3,3,3] row_mask:0xf bank_mask:0xf
  s_waitcnt lgkmcnt(0)
  v_max3_u32 v55, v56, v57, v58
  v_min3_u32 v54, v56, v57, v58
  v_max_u32 v55, v55, v59
  v_min_u32 v54, v54, v59
  v_sub_u32 v55, v55, v61
  v_sub_u32 v54, v61, v54
  v_cmp_le_u32 vcc, 2, v55
  v_cmp_eq_u32 s[30:31], 1, v62
  v_cmp_gt_u32 s[32:33], 4, v54
  s_and_b64 s[30:31], s[30:31], s[32:33]
  s_or_b64 vcc, vcc, s[30:31]
  s_waitcnt vmcnt(5)
  s_cbranch_vccnz L_w51
  s_waitcnt vmcnt(4)
L_w51:
  buffer_load_dwordx4 v[136:139], v1, s[8:11], s16 offen offset:1024 nt
  v_mfma_f32_16x16x32_bf16 v[28:31], v[184:187], v[8:11], 0
  v_add_f32_dpp v33, v21, v20 quad_perm:[1,1,1,1] row_mask:0xf bank_mask:0xf
  v_mfma_f32_16x16x32_bf16 v[28:31], v[188:191], v[12:15], v[28:31]
  s_nop 0
  v_add_f32_dpp v33, v22, v33 quad_perm:[2,2,2,2] row_mask:0xf bank_mask:0xf
  s_nop 1
  v_add_f32_dpp v33, v23, v33 quad_perm:[3,3,3,3] row_mask:0xf bank_mask:0xf
  v_mfma_f32_16x16x32_bf16 v[16:19], v[192:195], v[8:11], 0
  v_add_f32_dpp v34, v25, v24 quad_perm:[1,1,1,1] row_mask:0xf bank_mask:0xf
  v_cvt_pk_bf16_f32 v38, v32, v33
  v_max3_f32 v4, v4, v32, v33
  v_mfma_f32_16x16x32_bf16 v[16:19], v[196:199], v[12:15], v[16:19]
  v_add_f32_dpp v34, v26, v34 quad_perm:[2,2,2,2] row_mask:0xf bank_mask:0xf
  s_nop 1
  v_add_f32_dpp v34, v27, v34 quad_perm:[3,3,3,3] row_mask:0xf bank_mask:0xf
  v_mfma_f32_16x16x32_bf16 v[20:23], v[200:203], v[8:11], 0
  v_add_f32_dpp v35, v29, v28 quad_perm:[1,1,1,1] row_mask:0xf bank_mask:0xf
  v_mfma_f32_16x16x32_bf16 v[20:23], v[204:207], v[12:15], v[20:23]
  s_nop 0
  v_add_f32_dpp v35, v30, v35 quad_perm:[2,2,2,2] row_mask:0xf bank_mask:0xf
  s_nop 1
  v_add_f32_dpp v35, v31, v35 quad_perm:[3,3,3,3] row_mask:0xf bank_mask:0xf
  v_add_u32 v61, 2, v61
  ds_write_b32 v63, v61 offset:18512
  ds_read_b32 v62, v60 offset:18496
  ds_read_b128 v[56:59], v60 offset:18512
  s_waitcnt vmcnt(5)
  s_cbranch_vccnz L_w52
  s_waitcnt vmcnt(4)
L_w52:
  buffer_load_dwordx4 v[140:143], v1, s[8:11], s16 offen offset:1280 nt
  s_add_u32 s16, s16, s28
  v_mfma_f32_16x16x32_bf16 v[24:27], v[208:211], v[8:11], 0
  v_add_f32_dpp v32, v17, v16 quad_perm:[1,1,1,1] row_mask:0xf bank_mask:0xf
  v_cvt_pk_bf16_f32 v39, v34, v35
  v_max3_f32 v4, v4, v34, v35
  s_mov_b64 exec, s[24:25]
  ds_write_b128 v3, v[36:39]
  s_mov_b64 exec, -1
  v_add_u32 v3, 128, v3
  v_mfma_f32_16x16x32_bf16 v[24:27], v[212:215], v[12:15], v[24:27]
  v_add_f32_dpp v32, v18, v32 quad_perm:[2,2,2,2] row_mask:0xf bank_mask:0xf
  s_nop 1
  v_add_f32_dpp v32, v19, v32 quad_perm:[3,3,3,3] row_mask:0xf bank_mask:0xf
  v_mfma_f32_16x16x32_bf16 v[28:31], v[216:219], v[8:11], 0
  v_add_f32_dpp v33, v21, v20 quad_perm:[1,1,1,1] row_mask:0xf bank_mask:0xf
  v_mfma_f32_16x16x32_bf16 v[28:31], v[220:223], v[12:15], v[28:31]
  s_nop 0
  v_add_f32_dpp v33, v22, v33 quad_perm:[2,2,2,2] row_mask:0xf bank_mask:0xf
  s_nop 1
  v_add_f32_dpp v33, v23, v33 quad_perm:[3,3,3,3] row_mask:0xf bank_mask:0xf
  v_mfma_f32_16x16x32_bf16 v[16:19], v[224:227], v[8:11], 0
  v_add_f32_dpp v34, v25, v24 quad_perm:[1,1,1,1] row_mask:0xf bank_mask:0xf
  v_cvt_pk_bf16_f32 v36, v32, v33
  v_max3_f32 v4, v4, v32, v33
  v_mfma_f32_16x16x32_bf16 v[16:19], v[228:231], v[12:15], v[16:19]
  v_add_f32_dpp v34, v26, v34 quad_perm:[2,2,2,2] row_mask:0xf bank_mask:0xf
  s_nop 1
  v_add_f32_dpp v34, v27, v34 quad_perm:[3,3,3,3] row_mask:0xf bank_mask:0xf
  s_waitcnt lgkmcnt(0)
  v_max3_u32 v55, v56, v57, v58
  v_min3_u32 v54, v56, v57, v58
  v_max_u32 v55, v55, v59
  v_min_u32 v54, v54, v59
  v_sub_u32 v55, v55, v61
  v_sub_u32 v54, v61, v54
  v_cmp_le_u32 vcc, 2, v55
  v_cmp_eq_u32 s[30:31], 1, v62
  v_cmp_gt_u32 s[32:33], 4, v54
  s_and_b64 s[30:31], s[30:31], s[32:33]
  s_or_b64 vcc, vcc, s[30:31]
  s_waitcnt vmcnt(5)
  s_cbranch_vccnz L_w53
  s_waitcnt vmcnt(4)
L_w53:
  buffer_load_dwordx4 v[144:147], v1, s[8:11], s16 offen offset:0 nt
  v_mfma_f32_16x16x32_bf16 v[20:23], v[232:235], v[8:11], 0
  v_add_f32_dpp v35, v29, v28 quad_perm:[1,1,1,1] row_mask:0xf bank_mask:0xf
  v_mfma_f32_16x16x32_bf16 v[20:23], v[236:239], v[12:15], v[20:23]
  s_nop 0
  v_add_f32_dpp v35, v30, v35 quad_perm:[2,2,2,2] row_mask:0xf bank_mask:0xf
  s_nop 1
  v_add_f32_dpp v35, v31, v35 quad_perm:[3,3,3,3] row_mask:0xf bank_mask:0xf
  v_mfma_f32_16x16x32_bf16 v[24:27], v[240:243], v[8:11], 0
  v_add_f32_dpp v32, v17, v16 quad_perm:[1,1,1,1] row_mask:0xf bank_mask:0xf
  v_cvt_pk_bf16_f32 v37, v34, v35
  v_max3_f32 v4, v4, v34, v35
  v_mfma_f32_16x16x32_bf16 v[24:27], v[244:247], v[12:15], v[24:27]
  v_add_f32_dpp v32, v18, v32 quad_perm:[2,2,2,2] row_mask:0xf bank_mask:0xf
  s_nop 1
  v_add_f32_dpp v32, v19, v32 quad_perm:[3,3,3,3] row_mask:0xf bank_mask:0xf
  v_mfma_f32_16x16x32_bf16 v[28:31], v[248:251], v[8:11], 0
  v_add_f32_dpp v33, v21, v20 quad_perm:[1,1,1,1] row_mask:0xf bank_mask:0xf
  v_mfma_f32_16x16x32_bf16 v[28:31], v[252:255], v[12:15], v[28:31]
  s_nop 0
  v_add_f32_dpp v33, v22, v33 quad_perm:[2,2,2,2] row_mask:0xf bank_mask:0xf
  s_nop 1
  v_add_f32_dpp v33, v23, v33 quad_perm:[3,3,3,3] row_mask:0xf bank_mask:0xf
  v_add_u32 v61, 2, v61
  ds_write_b32 v63, v61 offset:18512
  ds_read_b32 v62, v60 offset:18496
  ds_read_b128 v[56:59], v60 offset:18512
  s_waitcnt vmcnt(5)
  s_cbranch_vccnz L_w54
  s_waitcnt vmcnt(4)
L_w54:
  buffer_load_dwordx4 v[148:151], v1, s[8:11], s16 offen offset:256 nt
  v_add_f32_dpp v34, v25, v24 quad_perm:[1,1,1,1] row_mask:0xf bank_mask:0xf
  v_cvt_pk_bf16_f32 v38, v32, v33
  v_max3_f32 v4, v4, v32, v33
  v_add_f32_dpp v34, v26, v34 quad_perm:[2,2,2,2] row_mask:0xf bank_mask:0xf
  s_nop 1
  v_add_f32_dpp v34, v27, v34 quad_perm:[3,3,3,3] row_mask:0xf bank_mask:0xf
  v_add_f32_dpp v35, v29, v28 quad_perm:[1,1,1,1] row_mask:0xf bank_mask:0xf
  s_nop 1
  v_add_f32_dpp v35, v30, v35 quad_perm:[2,2,2,2] row_mask:0xf bank_mask:0xf
  s_nop 1
  v_add_f32_dpp v35, v31, v35 quad_perm:[3,3,3,3] row_mask:0xf bank_mask:0xf
  v_cvt_pk_bf16_f32 v39, v34, v35
  v_max3_f32 v4, v4, v34, v35
  s_mov_b64 exec, s[24:25]
  ds_write_b128 v3, v[36:39]
  s_mov_b64 exec, -1
  v_add_u32 v3, 128, v3
  s_waitcnt lgkmcnt(0)
  v_max3_u32 v55, v56, v57, v58
  v_min3_u32 v54, v56, v57, v58
  v_max_u32 v55, v55, v59
  v_min_u32 v54, v54, v59
  v_sub_u32 v55, v55, v61
  v_sub_u32 v54, v61, v54
  v_cmp_le_u32 vcc, 2, v55
  v_cmp_eq_u32 s[30:31], 1, v62
  v_cmp_gt_u32 s[32:33], 4, v54
  s_and_b64 s[30:31], s[30:31], s[32:33]
  s_or_b64 vcc, vcc, s[30:31]
  s_waitcnt vmcnt(5)
  s_cbranch_vccnz L_w55
  s_waitcnt vmcnt(4)
L_w55:
  buffer_load_dwordx4 v[152:155], v1, s[8:11], s16 offen offset:1024 nt
  v_mov_b32_dpp v4, v4 quad_perm:[0,0,0,0] row_mask:0xf bank_mask:0xf
  v_add_u32 v3, 0xfffff800, v3
  ds_read_b128 v[40:43], v3
  v_add_u32 v3, 128, v3
  v_mov_b32 v52, v4
  s_nop 1
  v_permlane16_swap_b32 v4, v52
  v_max_f32 v4, v4, v52
  v_mov_b32 v52, v4
  s_nop 1
  v_permlane32_swap_b32 v4, v52
  v_max_f32 v4, v4, v52
  v_cvt_pk_bf16_f32 v4, v4, v4
  v_lshlrev_b32 v4, 16, v4
  v_mul_f32 v4, s20, v4
  s_waitcnt lgkmcnt(0)
  v_add_u32 v61, 2, v61
  ds_write_b32 v63, v61 offset:18512
  ds_read_b32 v62, v60 offset:18496
  ds_read_b128 v[56:59], v60 offset:18512
  s_waitcnt vmcnt(5)
  s_cbranch_vccnz L_w56
  s_waitcnt vmcnt(4)
L_w56:
  buffer_load_dwordx4 v[156:159], v1, s[8:11], s16 offen offset:1280 nt
  s_add_u32 s16, s16, s28
  v_lshlrev_b32 v44, 16, v40
  v_and_b32 v45, 0xffff0000, v40
  v_lshlrev_b32 v46, 16, v41
  v_and_b32 v47, 0xffff0000, v41
  v_lshlrev_b32 v48, 16, v42
  v_and_b32 v49, 0xffff0000, v42
  v_lshlrev_b32 v50, 16, v43
  v_and_b32 v51, 0xffff0000, v43
  v_fma_f32 v44, v44, s20, -v4
  v_fma_f32 v45, v45, s20, -v4
  v_fma_f32 v46, v46, s20, -v4
  v_fma_f32 v47, v47, s20, -v4
  v_fma_f32 v48, v48, s20, -v4
  v_fma_f32 v49, v49, s20, -v4
  v_fma_f32 v50, v50, s20, -v4
  v_fma_f32 v51, v51, s20, -v4
  v_exp_f32 v44, v44
  v_exp_f32 v45, v45
  s_waitcnt lgkmcnt(0)
  v_max3_u32 v55, v56, v57, v58
  v_min3_u32 v54, v56, v57, v58
  v_max_u32 v55, v55, v59
  v_min_u32 v54, v54, v59
  v_sub_u32 v55, v55, v61
  v_sub_u32 v54, v61, v54
  v_cmp_le_u32 vcc, 2, v55
  v_cmp_eq_u32 s[30:31], 1, v62
  v_cmp_gt_u32 s[32:33], 4, v54
  s_and_b64 s[30:31], s[30:31], s[32:33]
  s_or_b64 vcc, vcc, s[30:31]
  s_waitcnt vmcnt(5)
  s_cbranch_vccnz L_w57
  s_waitcnt vmcnt(4)
L_w57:
  buffer_load_dwordx4 v[160:163], v1, s[8:11], s16 offen offset:0 nt
  v_exp_f32 v46, v46
  v_exp_f32 v47, v47
  v_exp_f32 v48, v48
  v_exp_f32 v49, v49
  v_exp_f32 v50, v50
  v_exp_f32 v51, v51
  v_cvt_pk_bf16_f32 v36, v44, v45
  v_add_f32 v44, v44, v45
  v_cvt_pk_bf16_f32 v37, v46, v47
  v_add_f32 v46, v46, v47
  v_cvt_pk_bf16_f32 v38, v48, v49
  v_add_f32 v48, v48, v49
  v_cvt_pk_bf16_f32 v39, v50, v51
  v_add_f32 v50, v50, v51
  v_add_f32 v44, v44, v46
  v_add_f32 v48, v48, v50
  v_add_f32 v44, v44, v48
  v_add_f32 v5, v5, v44
  ds_read_b128 v[40:43], v3
  v_add_u32 v3, 128, v3
  v_add_u32 v61, 2, v61
  ds_write_b32 v63, v61 offset:18512
  ds_read_b32 v62, v60 offset:18496
  ds_read_b128 v[56:59], v60 offset:18512
  s_waitcnt vmcnt(5)
  s_cbranch_vccnz L_w58
  s_waitcnt vmcnt(4)
L_w58:
  buffer_load_dwordx4 v[164:167], v1, s[8:11], s16 offen offset:256 nt
  v_perm_b32 v16, v72, v64, s18
  v_perm_b32 v17, v88, v80, s18
  v_perm_b32 v18, v104, v96, s18
  v_perm_b32 v19, v120, v112, s18
  v_perm_b32 v20, v72, v64, s19
  v_perm_b32 v21, v88, v80, s19
  v_mfma_f32_16x16x32_bf16 v[192:195], v[36:39], v[16:19], 0
  v_perm_b32 v22, v104, v96, s19
  v_perm_b32 v23, v120, v112, s19
  v_perm_b32 v24, v73, v65, s18
  v_perm_b32 v25, v89, v81, s18
  s_waitcnt lgkmcnt(0)
  v_max3_u32 v55, v56, v57, v58
  v_min3_u32 v54, v56, v57, v58
  v_max_u32 v55, v55, v59
  v_min_u32 v54, v54, v59
  v_sub_u32 v55, v55, v61
  v_sub_u32 v54, v61, v54
  v_cmp_le_u32 vcc, 2, v55
  v_cmp_eq_u32 s[30:31], 1, v62
  v_cmp_gt_u32 s[32:33], 4, v54
  s_and_b64 s[30:31], s[30:31], s[32:33]
  s_or_b64 vcc, vcc, s[30:31]
  s_waitcnt vmcnt(5)
  s_cbranch_vccnz L_w59
  s_waitcnt vmcnt(4)
L_w59:
  buffer_load_dwordx4 v[168:171], v1, s[8:11], s16 offen offset:1024 nt
  v_mfma_f32_16x16x32_bf16 v[196:199], v[36:39], v[20:23], 0
  v_perm_b32 v26, v105, v97, s18
  v_perm_b32 v27, v121, v113, s18
  v_perm_b32 v28, v73, v65, s19
  v_perm_b32 v29, v89, v81, s19
  v_mfma_f32_16x16x32_bf16 v[200:203], v[36:39], v[24:27], 0
  v_perm_b32 v30, v105, v97, s19
  v_perm_b32 v31, v121, v113, s19
  v_perm_b32 v16, v74, v66, s18
  v_perm_b32 v17, v90, v82, s18
  v_mfma_f32_16x16x32_bf16 v[204:207], v[36:39], v[28:31], 0
  v_add_u32 v61, 2, v61
  ds_write_b32 v63, v61 offset:18512
  ds_read_b32 v62, v60 offset:18496
  ds_read_b128 v[56:59], v60 offset:18512
  s_waitcnt vmcnt(5)
  s_cbranch_vccnz L_w60
  s_waitcnt vmcnt(4)
L_w60:
  buffer_load_dwordx4 v[172:175], v1, s[8:11], s16 offen offset:1280 nt
  s_add_u32 s16, s16, s28
  v_perm_b32 v18, v106, v98, s18
  v_perm_b32 v19, v122, v114, s18
  v_perm_b32 v20, v74, v66, s19
  v_perm_b32 v21, v90, v82, s19
  v_mfma_f32_16x16x32_bf16 v[208:211], v[36:39], v[16:19], 0
  v_perm_b32 v22, v106, v98, s19
  v_perm_b32 v23, v122, v114, s19
  v_perm_b32 v24, v75, v67, s18
  v_perm_b32 v25, v91, v83, s18
  v_mfma_f32_16x16x32_bf16 v[212:215], v[36:39], v[20:23], 0
  v_perm_b32 v26, v107, v99, s18
  v_perm_b32 v27, v123, v115, s18
  s_waitcnt lgkmcnt(0)
  v_max3_u32 v55, v56, v57, v58
  v_min3_u32 v54, v56, v57, v58
  v_max_u32 v55, v55, v59
  v_min_u32 v54, v54, v59
  v_sub_u32 v55, v55, v61
  v_sub_u32 v54, v61, v54
  v_cmp_le_u32 vcc, 2, v55
  v_cmp_eq_u32 s[30:31], 1, v62
  v_cmp_gt_u32 s[32:33], 4, v54
  s_and_b64 s[30:31], s[30:31], s[32:33]
  s_or_b64 vcc, vcc, s[30:31]
  s_waitcnt vmcnt(5)
  s_cbranch_vccnz L_w61
  s_waitcnt vmcnt(4)
L_w61:
  buffer_load_dwordx4 v[176:179], v1, s[8:11], s16 offen offset:0 nt
  v_perm_b32 v28, v75, v67, s19
  v_perm_b32 v29, v91, v83, s19
  v_mfma_f32_16x16x32_bf16 v[216:219], v[36:39], v[24:27], 0
  v_perm_b32 v30, v107, v99, s19
  v_perm_b32 v31, v123, v115, s19
  v_perm_b32 v16, v76, v68, s18
  v_perm_b32 v17, v92, v84, s18
  v_mfma_f32_16x16x32_bf16 v[220:223], v[36:39], v[28:31], 0
  v_perm_b32 v18, v108, v100, s18
  v_perm_b32 v19, v124, v116, s18
  v_perm_b32 v20, v76, v68, s19
  v_add_u32 v61, 2, v61
  ds_write_b32 v63, v61 offset:18512
  ds_read_b32 v62, v60 offset:18496
  ds_read_b128 v[56:59], v60 offset:18512
  s_waitcnt vmcnt(5)
  s_cbranch_vccnz L_w62
  s_waitcnt vmcnt(4)
L_w62:
  buffer_load_dwordx4 v[180:183], v1, s[8:11], s16 offen offset:256 nt
  v_perm_b32 v21, v92, v84, s19
  v_mfma_f32_16x16x32_bf16 v[224:227], v[36:39], v[16:19], 0
  v_perm_b32 v22, v108, v100, s19
  v_perm_b32 v23, v124, v116, s19
  v_perm_b32 v24, v77, v69, s18
  v_perm_b32 v25, v93, v85, s18
  v_mfma_f32_16x16x32_bf16 v[228:231], v[36:39], v[20:23], 0
  v_perm_b32 v26, v109, v101, s18
  v_perm_b32 v27, v125, v117, s18
  v_perm_b32 v28, v77, v69, s19
  v_perm_b32 v29, v93, v85, s19
  v_mfma_f32_16x16x32_bf16 v[232:235], v[36:39], v[24:27], 0
  s_waitcnt lgkmcnt(0)
  v_max3_u32 v55, v56, v57, v58
  v_min3_u32 v54, v56, v57, v58
  v_max_u32 v55, v55, v59
  v_min_u32 v54, v54, v59
  v_sub_u32 v55, v55, v61
  v_sub_u32 v54, v61, v54
  v_cmp_le_u32 vcc, 2, v55
  v_cmp_eq_u32 s[30:31], 1, v62
  v_cmp_gt_u32 s[32:33], 4, v54
  s_and_b64 s[30:31], s[30:31], s[32:33]
  s_or_b64 vcc, vcc, s[30:31]
  s_waitcnt vmcnt(5)
  s_cbranch_vccnz L_w63
  s_waitcnt vmcnt(4)
L_w63:
  buffer_load_dwordx4 v[184:187], v1, s[8:11], s16 offen offset:1024 nt
  v_perm_b32 v30, v109, v101, s19
  v_perm_b32 v31, v125, v117, s19
  v_perm_b32 v16, v78, v70, s18
  v_perm_b32 v17, v94, v86, s18
  v_mfma_f32_16x16x32_bf16 v[236:239], v[36:39], v[28:31], 0
  v_perm_b32 v18, v110, v102, s18
  v_perm_b32 v19, v126, v118, s18
  v_perm_b32 v20, v78, v70, s19
  v_perm_b32 v21, v94, v86, s19
  v_mfma_f32_16x16x32_bf16 v[240:243], v[36:39], v[16:19], 0
  v_perm_b32 v22, v110, v102, s19
  v_add_u32 v61, 2, v61
  ds_write_b32 v63, v61 offset:18512
  ds_read_b32 v62, v60 offset:18496
  ds_read_b128 v[56:59], v60 offset:18512
  s_waitcnt vmcnt(5)
  s_cbranch_vccnz L_w64
  s_waitcnt vmcnt(4)
L_w64:
  buffer_load_dwordx4 v[188:191], v1, s[8:11], s16 offen offset:1280 nt
  s_add_u32 s16, s16, s28
  v_perm_b32 v23, v126, v118, s19
  v_perm_b32 v24, v79, v71, s18
  v_perm_b32 v25, v95, v87, s18
  v_mfma_f32_16x16x32_bf16 v[244:247], v[36:39], v[20:23], 0
  v_perm_b32 v26, v111, v103, s18
  v_perm_b32 v27, v127, v119, s18
  v_perm_b32 v28, v79, v71, s19
  v_perm_b32 v29, v95, v87, s19
  v_mfma_f32_16x16x32_bf16 v[248:251], v[36:39], v[24:27], 0
  v_perm_b32 v30, v111, v103, s19
  v_perm_b32 v31, v127, v119, s19
  s_nop 1
  v_mfma_f32_16x16x32_bf16 v[252:255], v[36:39], v[28:31], 0
  s_waitcnt lgkmcnt(0)
  v_max3_u32 v55, v56, v57, v58
  v_min3_u32 v54, v56, v57, v58
  v_max_u32 v55, v55, v59
  v_min_u32 v54, v54, v59
  v_sub_u32 v55, v55, v61
  v_sub_u32 v54, v61, v54
  v_cmp_le_u32 vcc, 2, v55
  v_cmp_eq_u32 s[30:31], 1, v62
  v_cmp_gt_u32 s[32:33], 4, v54
  s_and_b64 s[30:31], s[30:31], s[32:33]
  s_or_b64 vcc, vcc, s[30:31]
  s_mov_b32 s17, 0
L_vA:
  s_waitcnt vmcnt(5)
  s_cbranch_vccnz L_w65
  s_waitcnt vmcnt(4)
L_w65:
  buffer_load_dwordx4 v[64:67], v1, s[8:11], s16 offen offset:0 nt
  s_waitcnt lgkmcnt(0)
  v_lshlrev_b32 v44, 16, v40
  v_and_b32 v45, 0xffff0000, v40
  v_lshlrev_b32 v46, 16, v41
  v_and_b32 v47, 0xffff0000, v41
  v_lshlrev_b32 v48, 16, v42
  v_and_b32 v49, 0xffff0000, v42
  v_lshlrev_b32 v50, 16, v43
  v_and_b32 v51, 0xffff0000, v43
  v_fma_f32 v44, v44, s20, -v4
  v_add_u32 v61, 2, v61
  ds_write_b32 v63, v61 offset:18512
  ds_read_b32 v62, v60 offset:18496
  ds_read_b128 v[56:59], v60 offset:18512
  s_waitcnt vmcnt(5)
  s_cbranch_vccnz L_w66
  s_waitcnt vmcnt(4)
L_w66:
  buffer_load_dwordx4 v[68:71], v1, s[8:11], s16 offen offset:256 nt
  v_fma_f32 v45, v45, s20, -v4
  v_fma_f32 v46, v46, s20, -v4
  v_fma_f32 v47, v47, s20, -v4
  v_fma_f32 v48, v48, s20, -v4
  v_fma_f32 v49, v49, s20, -v4
  v_fma_f32 v50, v50, s20, -v4
  v_fma_f32 v51, v51, s20, -v4
  v_exp_f32 v44, v44
  v_exp_f32 v45, v45
  s_waitcnt lgkmcnt(0)
  v_max3_u32 v55, v56, v57, v58
  v_min3_u32 v54, v56, v57, v58
  v_max_u32 v55, v55, v59
  v_min_u32 v54, v54, v59
  v_sub_u32 v55, v55, v61
  v_sub_u32 v54, v61, v54
  v_cmp_le_u32 vcc, 2, v55
  v_cmp_eq_u32 s[30:31], 1, v62
  v_cmp_gt_u32 s[32:33], 4, v54
  s_and_b64 s[30:31], s[30:31], s[32:33]
  s_or_b64 vcc, vcc, s[30:31]
  s_waitcnt vmcnt(5)
  s_cbranch_vccnz L_w67
  s_waitcnt vmcnt(4)
L_w67:
  buffer_load_dwordx4 v[72:75], v1, s[8:11], s16 offen offset:1024 nt
  v_exp_f32 v46, v46
  v_exp_f32 v47, v47
  v_exp_f32 v48, v48
  v_exp_f32 v49, v49
  v_exp_f32 v50, v50
  v_exp_f32 v51, v51
  v_cvt_pk_bf16_f32 v36, v44, v45
  v_add_f32 v44, v44, v45
  v_cvt_pk_bf16_f32 v37, v46, v47
  v_add_u32 v61, 2, v61
  ds_write_b32 v63, v61 offset:18512
  ds_read_b32 v62, v60 offset:18496
  ds_read_b128 v[56:59], v60 offset:18512
  s_waitcnt vmcnt(5)
  s_cbranch_vccnz L_w68
  s_waitcnt vmcnt(4)
L_w68:
  buffer_load_dwordx4 v[76:79], v1, s[8:11], s16 offen offset:1280 nt
  s_add_u32 s16, s16, s28
  v_add_f32 v46, v46, v47
  v_cvt_pk_bf16_f32 v38, v48, v49
  v_add_f32 v48, v48, v49
  v_cvt_pk_bf16_f32 v39, v50, v51
  v_add_f32 v50, v50, v51
  v_add_f32 v44, v44, v46
  v_add_f32 v48, v48, v50
  v_add_f32 v44, v44, v48
  v_add_f32 v5, v5, v44
  ds_read_b128 v[40:43], v3
  v_add_u32 v3, 128, v3
  s_waitcnt lgkmcnt(0)
  v_max3_u32 v55, v56, v57, v58
  v_min3_u32 v54, v56, v57, v58
  v_max_u32 v55, v55, v59
  v_min_u32 v54, v54, v59
  v_sub_u32 v55, v55, v61
  v_sub_u32 v54, v61, v54
  v_cmp_le_u32 vcc, 2, v55
  v_cmp_eq_u32 s[30:31], 1, v62
  v_cmp_gt_u32 s[32:33], 4, v54
  s_and_b64 s[30:31], s[30:31], s[32:33]
  s_or_b64 vcc, vcc, s[30:31]
  s_waitcnt vmcnt(5)
  s_cbranch_vccnz L_w69
  s_waitcnt vmcnt(4)
L_w69:
  buffer_load_dwordx4 v[80:83], v1, s[8:11], s16 offen offset:0 nt
  v_add_u32 v61, 2, v61
  ds_write_b32 v63, v61 offset:18512
  ds_read_b32 v62, v60 offset:18496
  ds_read_b128 v[56:59], v60 offset:18512
  s_waitcnt vmcnt(5)
  s_cbranch_vccnz L_w70
  s_waitcnt vmcnt(4)
L_w70:
  buffer_load_dwordx4 v[84:87], v1, s[8:11], s16 offen offset:256 nt
  v_perm_b32 v16, v136, v128, s18
  v_perm_b32 v17, v152, v144, s18
  v_perm_b32 v18, v168, v160, s18
  v_perm_b32 v19, v184, v176, s18
  v_perm_b32 v20, v136, v128, s19
  v_perm_b32 v21, v152, v144, s19
  v_mfma_f32_16x16x32_bf16 v[192:195], v[36:39], v[16:19], v[192:195]
  s_waitcnt lgkmcnt(0)
  v_max3_u32 v55, v56, v57, v58
  v_min3_u32 v54, v56, v57, v58
  v_max_u32 v55, v55, v59
  v_min_u32 v54, v54, v59
  v_sub_u32 v55, v55, v61
  v_sub_u32 v54, v61, v54
  v_cmp_le_u32 vcc, 2, v55
  v_cmp_eq_u32 s[30:31], 1, v62
  v_cmp_gt_u32 s[32:33], 4, v54
  s_and_b64 s[30:31], s[30:31], s[32:33]
  s_or_b64 vcc, vcc, s[30:31]
  s_waitcnt vmcnt(5)
  s_cbranch_vccnz L_w71
  s_waitcnt vmcnt(4)
L_w71:
  buffer_load_dwordx4 v[88:91], v1, s[8:11], s16 offen offset:1024 nt
  v_perm_b32 v22, v168, v160, s19
  v_perm_b32 v23, v184, v176, s19
  v_perm_b32 v24, v137, v129, s18
  v_perm_b32 v25, v153, v145, s18
  v_mfma_f32_16x16x32_bf16 v[196:199], v[36:39], v[20:23], v[196:199]
  v_perm_b32 v26, v169, v161, s18
  v_perm_b32 v27, v185, v177, s18
  v_add_u32 v61, 2, v61
  ds_write_b32 v63, v61 offset:18512
  ds_read_b32 v62, v60 offset:18496
  ds_read_b128 v[56:59], v60 offset:18512
  s_waitcnt vmcnt(5)
  s_cbranch_vccnz L_w72
  s_waitcnt vmcnt(4)
L_w72:
  buffer_load_dwordx4 v[92:95], v1, s[8:11], s16 offen offset:1280 nt
  s_add_u32 s16, s16, s28
  v_perm_b32 v28, v137, v129, s19
  v_perm_b32 v29, v153, v145, s19
  v_mfma_f32_16x16x32_bf16 v[200:203], v[36:39], v[24:27], v[200:203]
  v_perm_b32 v30, v169, v161, s19
  v_perm_b32 v31, v185, v177, s19
  v_perm_b32 v16, v138, v130, s18
  v_perm_b32 v17, v154, v146, s18
  s_waitcnt lgkmcnt(0)
  v_max3_u32 v55, v56, v57, v58
  v_min3_u32 v54, v56, v57, v58
  v_max_u32 v55, v55, v59
  v_min_u32 v54, v54, v59
  v_sub_u32 v55, v55, v61
  v_sub_u32 v54, v61, v54
  v_cmp_le_u32 vcc, 2, v55
  v_cmp_eq_u32 s[30:31], 1, v62
  v_cmp_gt_u32 s[32:33], 4, v54
  s_and_b64 s[30:31], s[30:31], s[32:33]
  s_or_b64 vcc, vcc, s[30:31]
  s_waitcnt vmcnt(5)
  s_cbranch_vccnz L_w73
  s_waitcnt vmcnt(4)
L_w73:
  buffer_load_dwordx4 v[96:99], v1, s[8:11], s16 offen offset:0 nt
  v_mfma_f32_16x16x32_bf16 v[204:207], v[36:39], v[28:31], v[204:207]
  v_perm_b32 v18, v170, v162, s18
  v_perm_b32 v19, v186, v178, s18
  v_perm_b32 v20, v138, v130, s19
  v_perm_b32 v21, v154, v146, s19
  v_mfma_f32_16x16x32_bf16 v[208:211], v[36:39], v[16:19], v[208:211]
  v_perm_b32 v22, v170, v162, s19
  v_perm_b32 v23, v186, v178, s19
  v_add_u32 v61, 2, v61
  ds_write_b32 v63, v61 offset:18512
  ds_read_b32 v62, v60 offset:18496
  ds_read_b128 v[56:59], v60 offset:18512
  s_waitcnt vmcnt(5)
  s_cbranch_vccnz L_w74
  s_waitcnt vmcnt(4)
L_w74:
  buffer_load_dwordx4 v[100:103], v1, s[8:11], s16 offen offset:256 nt
  v_perm_b32 v24, v139, v131, s18
  v_perm_b32 v25, v155, v147, s18
  v_mfma_f32_16x16x32_bf16 v[212:215], v[36:39], v[20:23], v[212:215]
  v_perm_b32 v26, v171, v163, s18
  v_perm_b32 v27, v187, v179, s18
  v_perm_b32 v28, v139, v131, s19
  v_perm_b32 v29, v155, v147, s19
  s_waitcnt lgkmcnt(0)
  v_max3_u32 v55, v56, v57, v58
  v_min3_u32 v54, v56, v57, v58
  v_max_u32 v55, v55, v59
  v_min_u32 v54, v54, v59
  v_sub_u32 v55, v55, v61
  v_sub_u32 v54, v61, v54
  v_cmp_le_u32 vcc, 2, v55
  v_cmp_eq_u32 s[30:31], 1, v62
  v_cmp_gt_u32 s[32:33], 4, v54
  s_and_b64 s[30:31], s[30:31], s[32:33]
  s_or_b64 vcc, vcc, s[30:31]
  s_waitcnt vmcnt(5)
  s_cbranch_vccnz L_w75
  s_waitcnt vmcnt(4)
L_w75:
  buffer_load_dwordx4 v[104:107], v1, s[8:11], s16 offen offset:1024 nt
  v_mfma_f32_16x16x32_bf16 v[216:219], v[36:39], v[24:27], v[216:219]
  v_perm_b32 v30, v171, v163, s19
  v_perm_b32 v31, v187, v179, s19
  v_perm_b32 v16, v140, v132, s18
  v_perm_b32 v17, v156, v148, s18
  v_mfma_f32_16x16x32_bf16 v[220:223], v[36:39], v[28:31], v[220:223]
  v_perm_b32 v18, v172, v164, s18
  v_add_u32 v61, 2, v61
  ds_write_b32 v63, v61 offset:18512
  ds_read_b32 v62, v60 offset:18496
  ds_read_b128 v[56:59], v60 offset:18512
  s_waitcnt vmcnt(5)
  s_cbranch_vccnz L_w76
  s_waitcnt vmcnt(4)
L_w76:
  buffer_load_dwordx4 v[108:111], v1, s[8:11], s16 offen offset:1280 nt
  s_add_u32 s16, s16, s28
  v_perm_b32 v19, v188, v180, s18
  v_perm_b32 v20, v140, v132, s19
  v_perm_b32 v21, v156, v148, s19
  v_mfma_f32_16x16x32_bf16 v[224:227], v[36:39], v[16:19], v[224:227]
  v_perm_b32 v22, v172, v164, s19
  v_perm_b32 v23, v188, v180, s19
  v_perm_b32 v24, v141, v133, s18
  s_waitcnt lgkmcnt(0)
  v_max3_u32 v55, v56, v57, v58
  v_min3_u32 v54, v56, v57, v58
  v_max_u32 v55, v55, v59
  v_min_u32 v54, v54, v59
  v_sub_u32 v55, v55, v61
  v_sub_u32 v54, v61, v54
  v_cmp_le_u32 vcc, 2, v55
  v_cmp_eq_u32 s[30:31], 1, v62
  v_cmp_gt_u32 s[32:33], 4, v54
  s_and_b64 s[30:31], s[30:31], s[32:33]
  s_or_b64 vcc, vcc, s[30:31]
  s_waitcnt vmcnt(5)
  s_cbranch_vccnz L_w77
  s_waitcnt vmcnt(4)
L_w77:
  buffer_load_dwordx4 v[112:115], v1, s[8:11], s16 offen offset:0 nt
  v_perm_b32 v25, v157, v149, s18
  v_mfma_f32_16x16x32_bf16 v[228:231], v[36:39], v[20:23], v[228:231]
  v_perm_b32 v26, v173, v165, s18
  v_perm_b32 v27, v189, v181, s18
  v_perm_b32 v28, v141, v133, s19
  v_perm_b32 v29, v157, v149, s19
  v_mfma_f32_16x16x32_bf16 v[232:235], v[36:39], v[24:27], v[232:235]
  v_perm_b32 v30, v173, v165, s19
  v_add_u32 v61, 2, v61
  ds_write_b32 v63, v61 offset:18512
  ds_read_b32 v62, v60 offset:18496
  ds_read_b128 v[56:59], v60 offset:18512
  s_waitcnt vmcnt(5)
  s_cbranch_vccnz L_w78
  s_waitcnt vmcnt(4)
L_w78:
  buffer_load_dwordx4 v[116:119], v1, s[8:11], s16 offen offset:256 nt
  v_perm_b32 v31, v189, v181, s19
  v_perm_b32 v16, v142, v134, s18
  v_perm_b32 v17, v158, v150, s18
  v_mfma_f32_16x16x32_bf16 v[236:239], v[36:39], v[28:31], v[236:239]
  v_perm_b32 v18, v174, v166, s18
  v_perm_b32 v19, v190, v182, s18
  v_perm_b32 v20, v142, v134, s19
  s_waitcnt lgkmcnt(0)
  v_max3_u32 v55, v56, v57, v58
  v_min3_u32 v54, v56, v57, v58
  v_max_u32 v55, v55, v59
  v_min_u32 v54, v54, v59
  v_sub_u32 v55, v55, v61
  v_sub_u32 v54, v61, v54
  v_cmp_le_u32 vcc, 2, v55
  v_cmp_eq_u32 s[30:31], 1, v62
  v_cmp_gt_u32 s[32:33], 4, v54
  s_and_b64 s[30:31], s[30:31], s[32:33]
  s_or_b64 vcc, vcc, s[30:31]
  s_waitcnt vmcnt(5)
  s_cbranch_vccnz L_w79
  s_waitcnt vmcnt(4)
L_w79:
  buffer_load_dwordx4 v[120:123], v1, s[8:11], s16 offen offset:1024 nt
  v_perm_b32 v21, v158, v150, s19
  v_mfma_f32_16x16x32_bf16 v[240:243], v[36:39], v[16:19], v[240:243]
  v_perm_b32 v22, v174, v166, s19
  v_perm_b32 v23, v190, v182, s19
  v_perm_b32 v24, v143, v135, s18
  v_perm_b32 v25, v159, v151, s18
  v_mfma_f32_16x16x32_bf16 v[244:247], v[36:39], v[20:23], v[244:247]
  v_add_u32 v61, 2, v61
  ds_write_b32 v63, v61 offset:18512
  ds_read_b32 v62, v60 offset:18496
  ds_read_b128 v[56:59], v60 offset:18512
  s_waitcnt vmcnt(5)
  s_cbranch_vccnz L_w80
  s_waitcnt vmcnt(4)
L_w80:
  buffer_load_dwordx4 v[124:127], v1, s[8:11], s16 offen offset:1280 nt
  s_add_u32 s16, s16, s28
  v_perm_b32 v26, v175, v167, s18
  v_perm_b32 v27, v191, v183, s18
  v_perm_b32 v28, v143, v135, s19
  v_perm_b32 v29, v159, v151, s19
  v_mfma_f32_16x16x32_bf16 v[248:251], v[36:39], v[24:27], v[248:251]
  v_perm_b32 v30, v175, v167, s19
  v_perm_b32 v31, v191, v183, s19
  s_nop 1
  v_mfma_f32_16x16x32_bf16 v[252:255], v[36:39], v[28:31], v[252:255]
  s_waitcnt lgkmcnt(0)
  v_max3_u32 v55, v56, v57, v58
  v_min3_u32 v54, v56, v57, v58
  v_max_u32 v55, v55, v59
  v_min_u32 v54, v54, v59
  v_sub_u32 v55, v55, v61
  v_sub_u32 v54, v61, v54
  v_cmp_le_u32 vcc, 2, v55
  v_cmp_eq_u32 s[30:31], 1, v62
  v_cmp_gt_u32 s[32:33], 4, v54
  s_and_b64 s[30:31], s[30:31], s[32:33]
  s_or_b64 vcc, vcc, s[30:31]
  s_waitcnt vmcnt(5)
  s_cbranch_vccnz L_w81
  s_waitcnt vmcnt(4)
L_w81:
  buffer_load_dwordx4 v[128:131], v1, s[8:11], s16 offen offset:0 nt
  s_waitcnt lgkmcnt(0)
  v_lshlrev_b32 v44, 16, v40
  v_and_b32 v45, 0xffff0000, v40
  v_lshlrev_b32 v46, 16, v41
  v_and_b32 v47, 0xffff0000, v41
  v_lshlrev_b32 v48, 16, v42
  v_and_b32 v49, 0xffff0000, v42
  v_lshlrev_b32 v50, 16, v43
  v_and_b32 v51, 0xffff0000, v43
  v_fma_f32 v44, v44, s20, -v4
  v_add_u32 v61, 2, v61
  ds_write_b32 v63, v61 offset:18512
  ds_read_b32 v62, v60 offset:18496
  ds_read_b128 v[56:59], v60 offset:18512
  s_waitcnt vmcnt(5)
  s_cbranch_vccnz L_w82
  s_waitcnt vmcnt(4)
L_w82:
  buffer_load_dwordx4 v[132:135], v1, s[8:11], s16 offen offset:256 nt
  v_fma_f32 v45, v45, s20, -v4
  v_fma_f32 v46, v46, s20, -v4
  v_fma_f32 v47, v47, s20, -v4
  v_fma_f32 v48, v48, s20, -v4
  v_fma_f32 v49, v49, s20, -v4
  v_fma_f32 v50, v50, s20, -v4
  v_fma_f32 v51, v51, s20, -v4
  v_exp_f32 v44, v44
  v_exp_f32 v45, v45
  s_waitcnt lgkmcnt(0)
  v_max3_u32 v55, v56, v57, v58
  v_min3_u32 v54, v56, v57, v58
  v_max_u32 v55, v55, v59
  v_min_u32 v54, v54, v59
  v_sub_u32 v55, v55, v61
  v_sub_u32 v54, v61, v54
  v_cmp_le_u32 vcc, 2, v55
  v_cmp_eq_u32 s[30:31], 1, v62
  v_cmp_gt_u32 s[32:33], 4, v54
  s_and_b64 s[30:31], s[30:31], s[32:33]
  s_or_b64 vcc, vcc, s[30:31]
  s_waitcnt vmcnt(5)
  s_cbranch_vccnz L_w83
  s_waitcnt vmcnt(4)
L_w83:
  buffer_load_dwordx4 v[136:139], v1, s[8:11], s16 offen offset:1024 nt
  v_exp_f32 v46, v46
  v_exp_f32 v47, v47
  v_exp_f32 v48, v48
  v_exp_f32 v49, v49
  v_exp_f32 v50, v50
  v_exp_f32 v51, v51
  v_cvt_pk_bf16_f32 v36, v44, v45
  v_add_f32 v44, v44, v45
  v_cvt_pk_bf16_f32 v37, v46, v47
  v_add_u32 v61, 2, v61
  ds_write_b32 v63, v61 offset:18512
  ds_read_b32 v62, v60 offset:18496
  ds_read_b128 v[56:59], v60 offset:18512
  s_waitcnt vmcnt(5)
  s_cbranch_vccnz L_w84
  s_waitcnt vmcnt(4)
L_w84:
  buffer_load_dwordx4 v[140:143], v1, s[8:11], s16 offen offset:1280 nt
  s_add_u32 s16, s16, s28
  v_add_f32 v46, v46, v47
  v_cvt_pk_bf16_f32 v38, v48, v49
  v_add_f32 v48, v48, v49
  v_cvt_pk_bf16_f32 v39, v50, v51
  v_add_f32 v50, v50, v51
  v_add_f32 v44, v44, v46
  v_add_f32 v48, v48, v50
  v_add_f32 v44, v44, v48
  v_add_f32 v5, v5, v44
  ds_read_b128 v[40:43], v3
  v_add_u32 v3, 128, v3
  s_waitcnt lgkmcnt(0)
  v_max3_u32 v55, v56, v57, v58
  v_min3_u32 v54, v56, v57, v58
  v_max_u32 v55, v55, v59
  v_min_u32 v54, v54, v59
  v_sub_u32 v55, v55, v61
  v_sub_u32 v54, v61, v54
  v_cmp_le_u32 vcc, 2, v55
  v_cmp_eq_u32 s[30:31], 1, v62
  v_cmp_gt_u32 s[32:33], 4, v54
  s_and_b64 s[30:31], s[30:31], s[32:33]
  s_or_b64 vcc, vcc, s[30:31]
  s_waitcnt vmcnt(5)
  s_cbranch_vccnz L_w85
  s_waitcnt vmcnt(4)
L_w85:
  buffer_load_dwordx4 v[144:147], v1, s[8:11], s16 offen offset:0 nt
  v_add_u32 v61, 2, v61
  ds_write_b32 v63, v61 offset:18512
  ds_read_b32 v62, v60 offset:18496
  ds_read_b128 v[56:59], v60 offset:18512
  s_waitcnt vmcnt(5)
  s_cbranch_vccnz L_w86
  s_waitcnt vmcnt(4)
L_w86:
  buffer_load_dwordx4 v[148:151], v1, s[8:11], s16 offen offset:256 nt
  v_perm_b32 v16, v72, v64, s18
  v_perm_b32 v17, v88, v80, s18
  v_perm_b32 v18, v104, v96, s18
  v_perm_b32 v19, v120, v112, s18
  v_perm_b32 v20, v72, v64, s19
  v_perm_b32 v21, v88, v80, s19
  v_mfma_f32_16x16x32_bf16 v[192:195], v[36:39], v[16:19], v[192:195]
  s_waitcnt lgkmcnt(0)
  v_max3_u32 v55, v56, v57, v58
  v_min3_u32 v54, v56, v57, v58
  v_max_u32 v55, v55, v59
  v_min_u32 v54, v54, v59
  v_sub_u32 v55, v55, v61
  v_sub_u32 v54, v61, v54
  v_cmp_le_u32 vcc, 2, v55
  v_cmp_eq_u32 s[30:31], 1, v62
  v_cmp_gt_u32 s[32:33], 4, v54
  s_and_b64 s[30:31], s[30:31], s[32:33]
  s_or_b64 vcc, vcc, s[30:31]
  s_waitcnt vmcnt(5)
  s_cbranch_vccnz L_w87
  s_waitcnt vmcnt(4)
L_w87:
  buffer_load_dwordx4 v[152:155], v1, s[8:11], s16 offen offset:1024 nt
  v_perm_b32 v22, v104, v96, s19
  v_perm_b32 v23, v120, v112, s19
  v_perm_b32 v24, v73, v65, s18
  v_perm_b32 v25, v89, v81, s18
  v_mfma_f32_16x16x32_bf16 v[196:199], v[36:39], v[20:23], v[196:199]
  v_perm_b32 v26, v105, v97, s18
  v_perm_b32 v27, v121, v113, s18
  v_add_u32 v61, 2, v61
  ds_write_b32 v63, v61 offset:18512
  ds_read_b32 v62, v60 offset:18496
  ds_read_b128 v[56:59], v60 offset:18512
  s_waitcnt vmcnt(5)
  s_cbranch_vccnz L_w88
  s_waitcnt vmcnt(4)
L_w88:
  buffer_load_dwordx4 v[156:159], v1, s[8:11], s16 offen offset:1280 nt
  s_add_u32 s16, s16, s28
  v_perm_b32 v28, v73, v65, s19
  v_perm_b32 v29, v89, v81, s19
  v_mfma_f32_16x16x32_bf16 v[200:203], v[36:39], v[24:27], v[200:203]
  v_perm_b32 v30, v105, v97, s19
  v_perm_b32 v31, v121, v113, s19
  v_perm_b32 v16, v74, v66, s18
  v_perm_b32 v17, v90, v82, s18
  s_waitcnt lgkmcnt(0)
  v_max3_u32 v55, v56, v57, v58
  v_min3_u32 v54, v56, v57, v58
  v_max_u32 v55, v55, v59
  v_min_u32 v54, v54, v59
  v_sub_u32 v55, v55, v61
  v_sub_u32 v54, v61, v54
  v_cmp_le_u32 vcc, 2, v55
  v_cmp_eq_u32 s[30:31], 1, v62
  v_cmp_gt_u32 s[32:33], 4, v54
  s_and_b64 s[30:31], s[30:31], s[32:33]
  s_or_b64 vcc, vcc, s[30:31]
  s_waitcnt vmcnt(5)
  s_cbranch_vccnz L_w89
  s_waitcnt vmcnt(4)
L_w89:
  buffer_load_dwordx4 v[160:163], v1, s[8:11], s16 offen offset:0 nt
  v_mfma_f32_16x16x32_bf16 v[204:207], v[36:39], v[28:31], v[204:207]
  v_perm_b32 v18, v106, v98, s18
  v_perm_b32 v19, v122, v114, s18
  v_perm_b32 v20, v74, v66, s19
  v_perm_b32 v21, v90, v82, s19
  v_mfma_f32_16x16x32_bf16 v[208:211], v[36:39], v[16:19], v[208:211]
  v_perm_b32 v22, v106, v98, s19
  v_perm_b32 v23, v122, v114, s19
  v_add_u32 v61, 2, v61
  ds_write_b32 v63, v61 offset:18512
  ds_read_b32 v62, v60 offset:18496
  ds_read_b128 v[56:59], v60 offset:18512
  s_waitcnt vmcnt(5)
  s_cbranch_vccnz L_w90
  s_waitcnt vmcnt(4)
L_w90:
  buffer_load_dwordx4 v[164:167], v1, s[8:11], s16 offen offset:256 nt
  v_perm_b32 v24, v75, v67, s18
  v_perm_b32 v25, v91, v83, s18
  v_mfma_f32_16x16x32_bf16 v[212:215], v[36:39], v[20:23], v[212:215]
  v_perm_b32 v26, v107, v99, s18
  v_perm_b32 v27, v123, v115, s18
  v_perm_b32 v28, v75, v67, s19
  v_perm_b32 v29, v91, v83, s19
  s_waitcnt lgkmcnt(0)
  v_max3_u32 v55, v56, v57, v58
  v_min3_u32 v54, v56, v57, v58
  v_max_u32 v55, v55, v59
  v_min_u32 v54, v54, v59
  v_sub_u32 v55, v55, v61
  v_sub_u32 v54, v61, v54
  v_cmp_le_u32 vcc, 2, v55
  v_cmp_eq_u32 s[30:31], 1, v62
  v_cmp_gt_u32 s[32:33], 4, v54
  s_and_b64 s[30:31], s[30:31], s[32:33]
  s_or_b64 vcc, vcc, s[30:31]
  s_waitcnt vmcnt(5)
  s_cbranch_vccnz L_w91
  s_waitcnt vmcnt(4)
L_w91:
  buffer_load_dwordx4 v[168:171], v1, s[8:11], s16 offen offset:1024 nt
  v_mfma_f32_16x16x32_bf16 v[216:219], v[36:39], v[24:27], v[216:219]
  v_perm_b32 v30, v107, v99, s19
  v_perm_b32 v31, v123, v115, s19
  v_perm_b32 v16, v76, v68, s18
  v_perm_b32 v17, v92, v84, s18
  v_mfma_f32_16x16x32_bf16 v[220:223], v[36:39], v[28:31], v[220:223]
  v_perm_b32 v18, v108, v100, s18
  v_add_u32 v61, 2, v61
  ds_write_b32 v63, v61 offset:18512
  ds_read_b32 v62, v60 offset:18496
  ds_read_b128 v[56:59], v60 offset:18512
  s_waitcnt vmcnt(5)
  s_cbranch_vccnz L_w92
  s_waitcnt vmcnt(4)
L_w92:
  buffer_load_dwordx4 v[172:175], v1, s[8:11], s16 offen offset:1280 nt
  s_add_u32 s16, s16, s28
  v_perm_b32 v19, v124, v116, s18
  v_perm_b32 v20, v76, v68, s19
  v_perm_b32 v21, v92, v84, s19
  v_mfma_f32_16x16x32_bf16 v[224:227], v[36:39], v[16:19], v[224:227]
  v_perm_b32 v22, v108, v100, s19
  v_perm_b32 v23, v124, v116, s19
  v_perm_b32 v24, v77, v69, s18
  s_waitcnt lgkmcnt(0)
  v_max3_u32 v55, v56, v57, v58
  v_min3_u32 v54, v56, v57, v58
  v_max_u32 v55, v55, v59
  v_min_u32 v54, v54, v59
  v_sub_u32 v55, v55, v61
  v_sub_u32 v54, v61, v54
  v_cmp_le_u32 vcc, 2, v55
  v_cmp_eq_u32 s[30:31], 1, v62
  v_cmp_gt_u32 s[32:33], 4, v54
  s_and_b64 s[30:31], s[30:31], s[32:33]
  s_or_b64 vcc, vcc, s[30:31]
  s_waitcnt vmcnt(5)
  s_cbranch_vccnz L_w93
  s_waitcnt vmcnt(4)
L_w93:
  buffer_load_dwordx4 v[176:179], v1, s[8:11], s16 offen offset:0 nt
  v_perm_b32 v25, v93, v85, s18
  v_mfma_f32_16x16x32_bf16 v[228:231], v[36:39], v[20:23], v[228:231]
  v_perm_b32 v26, v109, v101, s18
  v_perm_b32 v27, v125, v117, s18
  v_perm_b32 v28, v77, v69, s19
  v_perm_b32 v29, v93, v85, s19
  v_mfma_f32_16x16x32_bf16 v[232:235], v[36:39], v[24:27], v[232:235]
  v_perm_b32 v30, v109, v101, s19
  v_add_u32 v61, 2, v61
  ds_write_b32 v63, v61 offset:18512
  ds_read_b32 v62, v60 offset:18496
  ds_read_b128 v[56:59], v60 offset:18512
  s_waitcnt vmcnt(5)
  s_cbranch_vccnz L_w94
  s_waitcnt vmcnt(4)
L_w94:
  buffer_load_dwordx4 v[180:183], v1, s[8:11], s16 offen offset:256 nt
  v_perm_b32 v31, v125, v117, s19
  v_perm_b32 v16, v78, v70, s18
  v_perm_b32 v17, v94, v86, s18
  v_mfma_f32_16x16x32_bf16 v[236:239], v[36:39], v[28:31], v[236:239]
  v_perm_b32 v18, v110, v102, s18
  v_perm_b32 v19, v126, v118, s18
  v_perm_b32 v20, v78, v70, s19
  s_waitcnt lgkmcnt(0)
  v_max3_u32 v55, v56, v57, v58
  v_min3_u32 v54, v56, v57, v58
  v_max_u32 v55, v55, v59
  v_min_u32 v54, v54, v59
  v_sub_u32 v55, v55, v61
  v_sub_u32 v54, v61, v54
  v_cmp_le_u32 vcc, 2, v55
  v_cmp_eq_u32 s[30:31], 1, v62
  v_cmp_gt_u32 s[32:33], 4, v54
  s_and_b64 s[30:31], s[30:31], s[32:33]
  s_or_b64 vcc, vcc, s[30:31]
  s_waitcnt vmcnt(5)
  s_cbranch_vccnz L_w95
  s_waitcnt vmcnt(4)
L_w95:
  buffer_load_dwordx4 v[184:187], v1, s[8:11], s16 offen offset:1024 nt
  v_perm_b32 v21, v94, v86, s19
  v_mfma_f32_16x16x32_bf16 v[240:243], v[36:39], v[16:19], v[240:243]
  v_perm_b32 v22, v110, v102, s19
  v_perm_b32 v23, v126, v118, s19
  v_perm_b32 v24, v79, v71, s18
  v_perm_b32 v25, v95, v87, s18
  v_mfma_f32_16x16x32_bf16 v[244:247], v[36:39], v[20:23], v[244:247]
  v_add_u32 v61, 2, v61
  ds_write_b32 v63, v61 offset:18512
  ds_read_b32 v62, v60 offset:18496
  ds_read_b128 v[56:59], v60 offset:18512
  s_waitcnt vmcnt(5)
  s_cbranch_vccnz L_w96
  s_waitcnt vmcnt(4)
L_w96:
  buffer_load_dwordx4 v[188:191], v1, s[8:11], s16 offen offset:1280 nt
  s_add_u32 s16, s16, s28
  v_perm_b32 v26, v111, v103, s18
  v_perm_b32 v27, v127, v119, s18
  v_perm_b32 v28, v79, v71, s19
  v_perm_b32 v29, v95, v87, s19
  v_mfma_f32_16x16x32_bf16 v[248:251], v[36:39], v[24:27], v[248:251]
  v_perm_b32 v30, v111, v103, s19
  v_perm_b32 v31, v127, v119, s19
  s_nop 1
  v_mfma_f32_16x16x32_bf16 v[252:255], v[36:39], v[28:31], v[252:255]
  s_waitcnt lgkmcnt(0)
  v_max3_u32 v55, v56, v57, v58
  v_min3_u32 v54, v56, v57, v58
  v_max_u32 v55, v55, v59
  v_min_u32 v54, v54, v59
  v_sub_u32 v55, v55, v61
  v_sub_u32 v54, v61, v54
  v_cmp_le_u32 vcc, 2, v55
  v_cmp_eq_u32 s[30:31], 1, v62
  v_cmp_gt_u32 s[32:33], 4, v54
  s_and_b64 s[30:31], s[30:31], s[32:33]
  s_or_b64 vcc, vcc, s[30:31]
  s_add_u32 s17, s17, 1
  s_cmp_eq_u32 s17, 7
  s_cbranch_scc0 L_vA
L_last:
  s_waitcnt lgkmcnt(0)
  v_lshlrev_b32 v44, 16, v40
  v_and_b32 v45, 0xffff0000, v40
  v_lshlrev_b32 v46, 16, v41
  v_and_b32 v47, 0xffff0000, v41
  v_lshlrev_b32 v48, 16, v42
  v_and_b32 v49, 0xffff0000, v42
  v_lshlrev_b32 v50, 16, v43
  v_and_b32 v51, 0xffff0000, v43
  v_fma_f32 v44, v44, s20, -v4
  v_fma_f32 v45, v45, s20, -v4
  v_fma_f32 v46, v46, s20, -v4
  v_fma_f32 v47, v47, s20, -v4
  v_fma_f32 v48, v48, s20, -v4
  v_fma_f32 v49, v49, s20, -v4
  v_fma_f32 v50, v50, s20, -v4
  v_fma_f32 v51, v51, s20, -v4
  v_exp_f32 v44, v44
  v_exp_f32 v45, v45
  v_exp_f32 v46, v46
  v_exp_f32 v47, v47
  v_exp_f32 v48, v48
  v_exp_f32 v49, v49
  v_exp_f32 v50, v50
  v_exp_f32 v51, v51
  v_cvt_pk_bf16_f32 v36, v44, v45
  v_add_f32 v44, v44, v45
  v_cvt_pk_bf16_f32 v37, v46, v47
  v_add_f32 v46, v46, v47
  v_cvt_pk_bf16_f32 v38, v48, v49
  v_add_f32 v48, v48, v49
  v_cvt_pk_bf16_f32 v39, v50, v51
  v_add_f32 v50, v50, v51
  v_add_f32 v44, v44, v46
  v_add_f32 v48, v48, v50
  v_add_f32 v44, v44, v48
  v_add_f32 v5, v5, v44
  v_perm_b32 v64, v136, v128, s18
  v_perm_b32 v68, v136, v128, s19
  v_perm_b32 v72, v137, v129, s18
  v_mov_b32 v52, v5
  v_perm_b32 v76, v137, v129, s19
  v_perm_b32 v80, v138, v130, s18
  v_perm_b32 v84, v138, v130, s19
  v_permlane16_swap_b32 v5, v52
  v_perm_b32 v88, v139, v131, s18
  v_perm_b32 v92, v139, v131, s19
  v_perm_b32 v96, v140, v132, s18
  v_add_f32 v5, v5, v52
  v_perm_b32 v100, v140, v132, s19
  v_perm_b32 v104, v141, v133, s18
  v_perm_b32 v108, v141, v133, s19
  v_mov_b32 v52, v5
  v_perm_b32 v112, v142, v134, s18
  v_perm_b32 v116, v142, v134, s19
  v_perm_b32 v120, v143, v135, s18
  v_permlane32_swap_b32 v5, v52
  v_perm_b32 v124, v143, v135, s19
  v_perm_b32 v65, v152, v144, s18
  v_perm_b32 v69, v152, v144, s19
  v_add_f32 v5, v5, v52
  v_perm_b32 v73, v153, v145, s18
  v_perm_b32 v77, v153, v145, s19
  v_perm_b32 v81, v154, v146, s18
  v_perm_b32 v85, v154, v146, s19
  v_perm_b32 v89, v155, v147, s18
  v_perm_b32 v93, v155, v147, s19
  v_perm_b32 v97, v156, v148, s18
  v_perm_b32 v101, v156, v148, s19
  v_perm_b32 v105, v157, v149, s18
  v_perm_b32 v109, v157, v149, s19
  v_perm_b32 v113, v158, v150, s18
  v_perm_b32 v117, v158, v150, s19
  v_perm_b32 v121, v159, v151, s18
  v_perm_b32 v125, v159, v151, s19
  s_mov_b64 exec, 0x11
  ds_write_b64 v7, v[4:5] offset:18432
  s_mov_b64 exec, -1
  s_waitcnt vmcnt(4)
  v_perm_b32 v66, v168, v160, s18
  v_perm_b32 v70, v168, v160, s19
  v_perm_b32 v74, v169, v161, s18
  v_perm_b32 v78, v169, v161, s19
  v_perm_b32 v82, v170, v162, s18
  v_perm_b32 v86, v170, v162, s19
  v_perm_b32 v90, v171, v163, s18
  v_perm_b32 v94, v171, v163, s19
  v_perm_b32 v98, v172, v164, s18
  v_perm_b32 v102, v172, v164, s19
  v_perm_b32 v106, v173, v165, s18
  v_perm_b32 v110, v173, v165, s19
  v_perm_b32 v114, v174, v166, s18
  v_perm_b32 v118, v174, v166, s19
  v_perm_b32 v122, v175, v167, s18
  v_perm_b32 v126, v175, v167, s19
  s_waitcnt vmcnt(3)
  s_cmp_eq_u32 s101, 1
  s_cbranch_scc1 L_nox
  s_barrier
L_nox:
  s_waitcnt vmcnt(1)
  v_perm_b32 v67, v184, v176, s18
  v_perm_b32 v71, v184, v176, s19
  v_perm_b32 v75, v185, v177, s18
  v_mfma_f32_16x16x32_bf16 v[192:195], v[36:39], v[64:67], v[192:195]
  v_perm_b32 v79, v185, v177, s19
  v_mfma_f32_16x16x32_bf16 v[196:199], v[36:39], v[68:71], v[196:199]
  v_perm_b32 v83, v186, v178, s18
  v_mfma_f32_16x16x32_bf16 v[200:203], v[36:39], v[72:75], v[200:203]
  v_perm_b32 v87, v186, v178, s19
  v_mfma_f32_16x16x32_bf16 v[204:207], v[36:39], v[76:79], v[204:207]
  v_perm_b32 v91, v187, v179, s18
  v_mfma_f32_16x16x32_bf16 v[208:211], v[36:39], v[80:83], v[208:211]
  v_perm_b32 v95, v187, v179, s19
  v_mfma_f32_16x16x32_bf16 v[212:215], v[36:39], v[84:87], v[212:215]
  v_mfma_f32_16x16x32_bf16 v[216:219], v[36:39], v[88:91], v[216:219]
  v_mfma_f32_16x16x32_bf16 v[220:223], v[36:39], v[92:95], v[220:223]
  s_waitcnt vmcnt(0)
  v_perm_b32 v99, v188, v180, s18
  v_perm_b32 v103, v188, v180, s19
  v_perm_b32 v107, v189, v181, s18
  v_mfma_f32_16x16x32_bf16 v[224:227], v[36:39], v[96:99], v[224:227]
  v_perm_b32 v111, v189, v181, s19
  v_mfma_f32_16x16x32_bf16 v[228:231], v[36:39], v[100:103], v[228:231]
  v_perm_b32 v115, v190, v182, s18
  v_mfma_f32_16x16x32_bf16 v[232:235], v[36:39], v[104:107], v[232:235]
  v_perm_b32 v119, v190, v182, s19
  v_mfma_f32_16x16x32_bf16 v[236:239], v[36:39], v[108:111], v[236:239]
  v_perm_b32 v123, v191, v183, s18
  v_mfma_f32_16x16x32_bf16 v[240:243], v[36:39], v[112:115], v[240:243]
  v_perm_b32 v127, v191, v183, s19
  v_mfma_f32_16x16x32_bf16 v[244:247], v[36:39], v[116:119], v[244:247]
  v_mfma_f32_16x16x32_bf16 v[248:251], v[36:39], v[120:123], v[248:251]
  v_mfma_f32_16x16x32_bf16 v[252:255], v[36:39], v[124:127], v[252:255]
  v_cndmask_b32 v52, v192, v224, s[26:27]
  v_cndmask_b32 v53, v196, v228, s[26:27]
  v_cndmask_b32 v54, v200, v232, s[26:27]
  v_cndmask_b32 v55, v204, v236, s[26:27]
  v_cndmask_b32 v56, v208, v240, s[26:27]
  s_nop 0
  v_cndmask_b32 v57, v212, v244, s[26:27]
  v_cndmask_b32 v58, v216, v248, s[26:27]
  v_cndmask_b32 v59, v220, v252, s[26:27]
  ds_write_b128 v6, v[52:55]
  ds_write_b128 v6, v[56:59] offset:16
  s_cmp_eq_u32 s101, 1
  s_waitcnt lgkmcnt(0)
  s_cbranch_scc1 L_hret
  s_barrier
  s_endpgm
L_codeend:
.section .rodata,"a"
.p2align 6
.amdhsa_kernel gated_mix__gqa_block_cached__swiglu_ffn__decode_kernel
  .amdhsa_next_free_vgpr 256
  .amdhsa_next_free_sgpr 102
  .amdhsa_accum_offset 256
  .amdhsa_group_segment_fixed_size 0
  .amdhsa_kernarg_size 104
  .amdhsa_user_sgpr_count 2
  .amdhsa_user_sgpr_kernarg_segment_ptr 1
  .amdhsa_system_sgpr_workgroup_id_x 1
  .amdhsa_float_denorm_mode_32 3
.end_amdhsa_kernel
```
